```python
import torch

def _softmax(x, axis=-1):
    return torch.softmax(x, dim=axis)
def _gelu(x):
    return torch.nn.functional.gelu(x, approximate="tanh")
def _silu(x):
    return torch.nn.functional.silu(x)
def _sigmoid(x):
    return torch.sigmoid(x)
def _layernorm(x, axis=-1, eps=1e-5):
    m = x.mean(dim=axis, keepdim=True)
    v = x.var(dim=axis, keepdim=True, unbiased=False)
    return (x - m) / torch.sqrt(v + eps)
def _scatter_add(tgt, idx, src, axis=0):
    return tgt.clone().index_add_(axis, idx, src)
def _segment_sum(src, seg, n):
    out = torch.zeros((n,) + src.shape[1:], dtype=src.dtype)
    return out.index_add_(0, seg, src)
def _pad(x, pw):
    flat = tuple(v for pair in reversed(pw) for v in pair)
    return torch.nn.functional.pad(x, flat)

kernel_name = 'recurrent_scan__spectral_gfnet__geglu_ffn__prompt'

def setup_inputs():

    _w = (lambda a: (lambda t: t.to(torch.bfloat16) if t.is_floating_point() else t)(torch.as_tensor(a)))
    def _A_setup():
        B, S, D = 1, 2048, 640
        Df = D // 2 + 1
        return {
            "x": _w((lambda *s: torch.randn(*s, dtype=torch.bfloat16) * 0.05)(B, S, D)),
            "w_r": _w((lambda *s: torch.randn(*s, dtype=torch.bfloat16) * 0.05)(S, Df) * 0.02),
            "w_i": _w((lambda *s: torch.randn(*s, dtype=torch.bfloat16) * 0.05)(S, Df) * 0.02),
        }
    _A_in = _A_setup()

    def _B_setup():
        B, S, D, F = 1, 2048, 640, 1536
        return {
            "x": _w((lambda *s: torch.randn(*s, dtype=torch.bfloat16) * 0.05)(B, S, D)),
            "w_gate": _w((lambda *s: torch.randn(*s, dtype=torch.bfloat16) * 0.05)(D, F)),
            "w_up": _w((lambda *s: torch.randn(*s, dtype=torch.bfloat16) * 0.05)(D, F)),
            "w_down": _w((lambda *s: torch.randn(*s, dtype=torch.bfloat16) * 0.05)(F, D)),
        }
    _B_in = _B_setup()

    return {
        "A_x": _A_in["x"],
        "A_w_r": _A_in["w_r"],
        "A_w_i": _A_in["w_i"],
        "B_x": _B_in["x"],
        "B_w_gate": _B_in["w_gate"],
        "B_w_up": _B_in["w_up"],
        "B_w_down": _B_in["w_down"],
    }

def reference(A_x, A_w_r, A_w_i, B_x, B_w_gate, B_w_up, B_w_down):
    def _A_ref(x, w_r, w_i):
        B, S, D = x.shape
        X = (lambda x, axes=(-2,-1): torch.fft.rfft2(x.float(), dim=axes))(x, axes=(-2, -1))
        W = w_r + 1j * w_i
        X = X * W
        y = (lambda x, s, axes=(-2,-1): torch.fft.irfft2(x, s=s, dim=axes).to(torch.bfloat16))(X, (S, D), axes=(-2, -1))
        return y

    def _B_ref(x, w_gate, w_up, w_down):
        return (_gelu(x @ w_gate) * (x @ w_up)) @ w_down

    x = A_x
    xn = _layernorm(x, axis=-1)
    s = _A_ref(xn, A_w_r, A_w_i)
    g = _silu(_B_ref(xn, B_w_gate, B_w_up, B_w_down))
    return x + s * g
```

```asm
; @launch grid=(512,1,1) block=(256,1,1) lds=81920
.amdgcn_target "amdgcn-amd-amdhsa--gfx950"
.text
.p2align 12
.globl recurrent_scan__spectral_gfnet__geglu_ffn__prompt_kernel
.p2align 8
.type recurrent_scan__spectral_gfnet__geglu_ffn__prompt_kernel,@function
recurrent_scan__spectral_gfnet__geglu_ffn__prompt_kernel:
s_cmp_ge_u32 s2, 512
s_cbranch_scc1 L_end
s_load_dwordx16 s[4:19], s[0:1], 0
s_load_dwordx4 s[20:23], s[0:1], 64
v_lshrrev_b32 v1, 6, v0
s_and_b32 s25, s2, 255
v_readfirstlane_b32 s24, v1
v_and_b32 v1, 63, v0
v_lshlrev_b32 v4, 7, v1
s_and_b32 s26, s2, 1
s_lshl_b32 s26, s26, 2
s_bfe_u32 s27, s2, 0x20001
s_add_u32 s26, s26, s27
s_cmp_lt_u32 s2, 256
s_cbranch_scc1 L_ffn
L_aux:
s_setprio 2
s_lshr_b32 s60, s25, 3
s_lshl_b32 s27, s26, 5
s_add_u32 s27, s27, s60
s_lshl_b32 s58, s26, 2
s_add_u32 s58, s58, s24
s_lshl_b32 s58, s58, 5
s_add_u32 s58, s58, s60
s_mul_i32 s58, s58, 1280
s_add_u32 s59, s58, 1310720
v_lshlrev_b32 v22, 4, v1
v_lshlrev_b32 v23, 2, v1
v_lshrrev_b32 v24, 4, v1
v_and_b32 v25, 15, v1
v_cvt_f32_u32 v26, v25
v_cvt_f32_u32 v27, v24
s_waitcnt lgkmcnt(0)
s_mov_b64 s[28:29], s[22:23]
s_mov_b32 s30, 26738688
s_mov_b32 s31, 0x00020000
s_mov_b64 s[32:33], s[20:21]
s_mov_b32 s34, 256
s_mov_b32 s35, 0x00020000
s_mov_b64 s[48:49], s[4:5]
s_mov_b32 s50, 2621440
s_mov_b32 s51, 0x00020000
s_lshl_b32 s38, s25, 2
s_add_u32 s38, s38, s24
s_cmp_lg_u32 s38, 1
s_cbranch_scc1 ep_19
s_mov_b32 s38, 19009536
s_mov_b32 s36, 19005440
v_mov_b64 v[58:59], 0
v_mov_b64 v[60:61], 0
buffer_load_dword v2, off, s[28:31], s36 sc1
buffer_store_dwordx4 v[58:61], v22, s[28:31], s38 offen offset:0 sc1
buffer_store_dwordx4 v[58:61], v22, s[28:31], s38 offen offset:1024 sc1
buffer_store_dwordx4 v[58:61], v22, s[28:31], s38 offen offset:2048 sc1
buffer_store_dwordx4 v[58:61], v22, s[28:31], s38 offen offset:3072 sc1
s_mov_b64 exec, -1
ep_19:
buffer_load_dwordx4 v[10:13], v22, s[48:51], s58 offen
buffer_load_dwordx4 v[16:19], v22, s[48:51], s59 offen
buffer_load_dword v14, v23, s[48:51], s58 offen offset:1024
buffer_load_dword v20, v23, s[48:51], s59 offen offset:1024
s_cmp_lt_u32 s24, 2
s_cselect_b64 s[52:53], s[6:7], s[8:9]
s_mov_b32 s54, 1314816
s_mov_b32 s55, 0x00020000
s_and_b32 s57, s24, 1
s_mul_i32 s57, s57, 3072
s_mul_i32 s56, s27, 5136
s_add_u32 s56, s56, s57
s_sub_u32 s56, s56, 656
v_add_u32 v6, s56, v22
v_add_u32 v7, 1314816, v6
v_min_u32 v7, v6, v7
v_add_u32 v6, 1024, v6
s_mul_i32 s57, s24, 3072
s_add_u32 m0, s57, 0
s_nop 0
buffer_load_dwordx4 v7, s[52:55], 0 offen lds
s_add_u32 m0, s57, 1024
s_nop 0
buffer_load_dwordx4 v6, s[52:55], 0 offen lds
buffer_load_dwordx4 v6, s[52:55], 0 offen offset:1024 lds
s_branch S_A1
L_ffn:
s_lshr_b32 s3, s25, 3
s_xor_b32 s38, s24, 0
s_lshl_b32 s38, s38, 5
s_add_u32 s3, s38, s3
s_cmp_ge_u32 s3, 39
s_cbranch_scc1 pf_1
s_getpc_b64 s[78:79]
pc_2:
s_lshl_b32 s3, s3, 10
s_sub_u32 s3, s3, pc_2-recurrent_scan__spectral_gfnet__geglu_ffn__prompt_kernel
s_ashr_i32 s38, s3, 31
s_add_u32 s3, s3, s78
s_addc_u32 s38, s38, s79
v_lshlrev_b32 v8, 4, v1
v_mov_b32 v9, s38
v_add_co_u32 v8, vcc, s3, v8
s_nop 1
v_addc_co_u32 v9, vcc, 0, v9, vcc
global_load_dwordx4 v[16:19], v[8:9], off
pf_1:
s_and_b32 s61, s24, 1
s_lshr_b32 s62, s24, 1
s_and_b32 s52, s25, 0
v_bfe_u32 v6, v1, 3, 2
v_lshrrev_b32 v7, 5, v1
v_lshl_add_u32 v6, v7, 5, v6
v_mul_u32_u24 v6, 2560, v6
v_lshrrev_b32 v7, 4, v1
v_xor_b32 v7, v7, v1
v_and_b32 v7, 7, v7
v_add_lshl_u32 v100, v6, v7, 4
v_xor_b32 v101, 64, v100
v_add_u32 v101, 1280, v101
s_cmp_ge_u32 s25, 240
s_cbranch_scc1 L_mid
s_lshr_b32 s48, s25, 3
s_mul_i32 s49, s48, 52
s_lshr_b32 s49, s49, 8
s_mul_i32 s50, s49, 5
s_sub_u32 s50, s48, s50
s_mul_i32 s50, s50, 24
s_and_b32 s48, s25, 6
s_lshl_b32 s51, s48, 1
s_lshr_b32 s51, 0x2004, s51
s_and_b32 s51, s51, 15
s_add_u32 s49, s49, s51
s_sub_u32 s51, s49, 6
s_cselect_b32 s51, s49, s51
s_mul_i32 s48, s48, 3
s_add_u32 s51, s51, s48
s_lshl_b32 s51, s51, 2
s_and_b32 s48, s25, 1
s_mul_i32 s48, s48, 136
s_add_u32 s50, s50, s48
v_lshrrev_b32 v7, 3, v1
v_and_b32 v8, 2, v7
s_lshl_b32 s49, s62, 2
v_xor_b32 v8, s49, v8
v_and_b32 v6, 7, v1
v_xor_b32 v6, v6, v8
v_mul_u32_u24 v7, 192, v7
v_add_lshl_u32 v96, v7, v6, 4
v_add_u32 v97, 24576, v96
s_lshl_b32 s56, s52, 2
s_add_u32 s56, s56, s61
s_mul_i32 s56, s56, 49152
s_lshl_b32 s48, s51, 5
s_add_u32 s56, s56, s48
s_mul_i32 s60, s24, 2048
s_mul_i32 s59, s24, 6
s_add_u32 s48, s59, s50
s_lshr_b32 s49, s48, 5
s_mul_i32 s49, s49, 96
s_add_u32 s48, s48, s49
s_mul_i32 s48, s48, 10
s_add_u32 s48, s48, s52
s_lshl_b32 s53, s48, 7
s_add_u32 s48, s59, s50
s_add_u32 s48, s48, 2
s_lshr_b32 s49, s48, 5
s_mul_i32 s49, s49, 96
s_add_u32 s48, s48, s49
s_mul_i32 s48, s48, 10
s_add_u32 s48, s48, s52
s_lshl_b32 s54, s48, 7
s_add_u32 s48, s59, s50
s_add_u32 s48, s48, 4
s_lshr_b32 s49, s48, 5
s_mul_i32 s49, s49, 96
s_add_u32 s48, s48, s49
s_mul_i32 s48, s48, 10
s_add_u32 s48, s48, s52
s_lshl_b32 s55, s48, 7
s_lshl_b32 s59, s59, 10
s_waitcnt lgkmcnt(0)
s_mov_b64 s[28:29], s[22:23]
s_mov_b32 s30, 26738688
s_mov_b32 s31, 0x00020000
s_mov_b64 s[32:33], s[20:21]
s_mov_b32 s34, 256
s_mov_b32 s35, 0x00020000
s_mov_b64 s[40:41], s[4:5]
s_mov_b32 s42, 2621440
s_mov_b32 s43, 0x00020000
s_cmp_lt_u32 s24, 2
s_cselect_b64 s[44:45], s[12:13], s[14:15]
s_mov_b32 s46, 1966080
s_mov_b32 s47, 0x00020000
s_add_u32 m0, s60, 0
s_nop 0
buffer_load_dwordx4 v96, s[44:47], s56 offen lds
s_add_u32 m0, s60, 1024
s_nop 0
buffer_load_dwordx4 v97, s[44:47], s56 offen lds
s_add_u32 m0, s59, 32768
s_nop 0
buffer_load_dwordx4 v100, s[40:43], s53 offen lds
s_add_u32 m0, s59, 33792
s_nop 0
buffer_load_dwordx4 v101, s[40:43], s53 offen lds
s_add_u32 m0, s59, 34816
s_nop 0
buffer_load_dwordx4 v100, s[40:43], s54 offen lds
s_add_u32 m0, s59, 35840
s_nop 0
buffer_load_dwordx4 v101, s[40:43], s54 offen lds
s_add_u32 m0, s59, 36864
s_nop 0
buffer_load_dwordx4 v100, s[40:43], s55 offen lds
s_add_u32 m0, s59, 37888
s_nop 0
buffer_load_dwordx4 v101, s[40:43], s55 offen lds
v_and_b32 v6, 31, v1
v_lshrrev_b32 v7, 5, v1
v_bfe_u32 v8, v1, 1, 3
v_xor_b32 v8, v8, v7
s_mul_i32 s48, s62, 12288
s_add_u32 s48, s48, 32768
v_lshlrev_b32 v6, 7, v6
v_add_u32 v6, s48, v6
v_lshl_add_u32 v252, v8, 4, v6
v_xor_b32 v253, 32, v252
v_xor_b32 v254, 64, v252
v_xor_b32 v255, 96, v252
v_bfe_u32 v6, v1, 2, 2
v_lshl_add_u32 v6, v7, 3, v6
v_bfe_u32 v8, v1, 4, 1
v_lshl_add_u32 v6, v8, 5, v6
v_mul_u32_u24 v6, 128, v6
v_and_b32 v9, 3, v1
v_lshl_add_u32 v6, v9, 3, v6
v_bfe_u32 v8, v1, 3, 2
s_mov_b32 s48, s61
s_add_u32 s49, s48, 2
v_xor_b32 v9, s48, v8
v_lshl_add_u32 v102, v9, 5, v6
v_xor_b32 v9, s49, v8
v_lshl_add_u32 v103, v9, 5, v6
v_mov_b64 v[116:117], 0
v_mov_b64 v[118:119], 0
v_mov_b64 v[120:121], 0
v_mov_b64 v[122:123], 0
v_mov_b64 v[124:125], 0
v_mov_b64 v[126:127], 0
v_mov_b64 v[128:129], 0
v_mov_b64 v[130:131], 0
v_mov_b64 v[132:133], 0
v_mov_b64 v[134:135], 0
v_mov_b64 v[136:137], 0
v_mov_b64 v[138:139], 0
v_mov_b64 v[140:141], 0
v_mov_b64 v[142:143], 0
v_mov_b64 v[144:145], 0
v_mov_b64 v[146:147], 0
v_mov_b64 v[148:149], 0
v_mov_b64 v[150:151], 0
v_mov_b64 v[152:153], 0
v_mov_b64 v[154:155], 0
v_mov_b64 v[156:157], 0
v_mov_b64 v[158:159], 0
v_mov_b64 v[160:161], 0
v_mov_b64 v[162:163], 0
v_mov_b64 v[164:165], 0
v_mov_b64 v[166:167], 0
v_mov_b64 v[168:169], 0
v_mov_b64 v[170:171], 0
v_mov_b64 v[172:173], 0
v_mov_b64 v[174:175], 0
v_mov_b64 v[176:177], 0
v_mov_b64 v[178:179], 0
v_mov_b64 v[180:181], 0
v_mov_b64 v[182:183], 0
v_mov_b64 v[184:185], 0
v_mov_b64 v[186:187], 0
v_mov_b64 v[188:189], 0
v_mov_b64 v[190:191], 0
v_mov_b64 v[192:193], 0
v_mov_b64 v[194:195], 0
v_mov_b64 v[196:197], 0
v_mov_b64 v[198:199], 0
v_mov_b64 v[200:201], 0
v_mov_b64 v[202:203], 0
v_mov_b64 v[204:205], 0
v_mov_b64 v[206:207], 0
v_mov_b64 v[208:209], 0
v_mov_b64 v[210:211], 0
v_mov_b64 v[232:233], 0
v_mov_b64 v[234:235], 0
v_mov_b64 v[236:237], 0
v_mov_b64 v[238:239], 0
v_mov_b64 v[84:85], 0
v_mov_b64 v[86:87], 0
v_mov_b64 v[88:89], 0
v_mov_b64 v[90:91], 0
v_mov_b64 v[92:93], 0
v_mov_b64 v[94:95], 0
s_lshl_b32 s48, s26, 2
s_bfe_u32 s49, s25, 0x20003
s_add_u32 s63, s48, s49
s_lshr_b32 s64, s25, 5
s_and_b32 s48, s26, 6
s_lshl_b32 s48, s48, 2
s_bfe_u32 s49, s25, 0x30003
s_add_u32 s63, s48, s49
s_and_b32 s48, s26, 1
s_lshl_b32 s48, s48, 2
s_lshr_b32 s49, s25, 6
s_add_u32 s64, s48, s49
s_min_u32 s48, s26, 5
s_lshl_b32 s65, s48, 13
s_mov_b32 s49, 49152
s_add_u32 s66, s65, 8192
s_cmp_eq_u32 s66, s49
s_cselect_b32 s66, 0, s66
s_add_u32 s67, s66, 8192
s_cmp_eq_u32 s67, s49
s_cselect_b32 s67, 0, s67
s_add_u32 s68, s67, 8192
s_cmp_eq_u32 s68, s49
s_cselect_b32 s68, 0, s68
s_add_u32 s69, s68, 8192
s_cmp_eq_u32 s69, s49
s_cselect_b32 s69, 0, s69
s_add_u32 s70, s69, 8192
s_cmp_eq_u32 s70, s49
s_cselect_b32 s70, 0, s70
s_add_u32 s71, s65, 4096
s_add_u32 s72, s66, 4096
s_add_u32 s73, s67, 4096
s_add_u32 s74, s68, 4096
s_add_u32 s75, s69, 4096
s_add_u32 s76, s70, 4096
s_mul_i32 s49, s24, s49
v_lshl_add_u32 v6, v1, 4, s49
s_mul_i32 s48, s63, 196608
s_add_u32 s48, s48, 10485760
v_add_u32 v10, s48, v6
s_mul_i32 s48, s64, 196608
s_add_u32 s48, s48, 16777216
v_add_u32 v11, s48, v6
s_lshr_b32 s48, s64, 2
s_mul_i32 s48, s48, 196608
s_and_b32 s49, s64, 3
s_lshl_b32 s49, s49, 10
s_add_u32 s48, s48, s49
s_add_u32 s48, s48, 18350080
v_add_u32 v12, s48, v6
s_cmp_eq_u32 s24, 0
s_cbranch_scc1 T_A2
s_cmp_eq_u32 s24, 1
s_cbranch_scc1 T_L
s_cmp_eq_u32 s24, 2
s_cbranch_scc1 T_C
s_branch T_P
L_touched:
s_add_u32 s57, s56, 98304
s_add_u32 m0, s60, 8192
s_nop 0
buffer_load_dwordx4 v96, s[44:47], s57 offen lds
s_add_u32 m0, s60, 9216
s_nop 0
buffer_load_dwordx4 v97, s[44:47], s57 offen lds
s_movk_i32 s49, 128
s_add_u32 s52, s52, 1
s_cmp_eq_u32 s52, 10
s_cselect_b32 s52, 0, s52
s_cselect_b32 s48, 4294966144, s49
s_add_u32 s53, s53, s48
s_add_u32 s54, s54, s48
s_add_u32 s55, s55, s48
s_mul_i32 s48, s48, 1536
s_add_u32 s56, s56, s48
s_add_u32 m0, s59, 57344
s_nop 0
buffer_load_dwordx4 v100, s[40:43], s53 offen lds
s_add_u32 m0, s59, 58368
s_nop 0
buffer_load_dwordx4 v101, s[40:43], s53 offen lds
s_add_u32 m0, s59, 59392
s_nop 0
buffer_load_dwordx4 v100, s[40:43], s54 offen lds
s_add_u32 m0, s59, 60416
s_nop 0
buffer_load_dwordx4 v101, s[40:43], s54 offen lds
s_add_u32 m0, s59, 61440
s_nop 0
buffer_load_dwordx4 v100, s[40:43], s55 offen lds
s_add_u32 m0, s59, 62464
s_nop 0
buffer_load_dwordx4 v101, s[40:43], s55 offen lds
s_add_u32 s53, s53, 128
s_add_u32 s54, s54, 128
s_add_u32 s55, s55, 128
s_branch S_L
.p2align 12
T_Q:
s_branch L_touched
S_Q:
s_waitcnt vmcnt(8)
s_barrier
s_cmp_lg_u32 s24, 0
s_cbranch_scc1 ag_11
s_mov_b32 exec_lo, s58
s_mov_b32 exec_hi, 0
buffer_atomic_add v2, v4, s[28:31], s59 offen offset:256 sc1
s_cmp_eq_u32 s27, 8
s_cbranch_scc1 ag_12
buffer_atomic_add v2, v4, s[28:31], s59 offen sc1
ag_12:
s_mov_b64 exec, -1
ag_11:
s_lshl_b32 s50, s55, 1
s_lshl_b32 s38, s50, 8
s_add_u32 s38, s38, 18874496
s_load_dword s36, s[22:23], s38 glc
s_add_u32 m0, s60, 10240
s_nop 0
buffer_load_dwordx4 v11, s[28:31], s72 offen sc1 lds
s_add_u32 m0, s60, 10240
s_nop 0
buffer_load_dwordx4 v11, s[28:31], s72 offen offset:1024 sc1 lds
s_add_u32 m0, s60, 10240
s_nop 0
buffer_load_dwordx4 v11, s[28:31], s72 offen offset:2048 sc1 lds
s_add_u32 m0, s60, 10240
s_nop 0
buffer_load_dwordx4 v11, s[28:31], s72 offen offset:3072 sc1 lds
s_add_u32 m0, s60, 14336
s_nop 0
buffer_load_dwordx4 v12, s[28:31], s72 offen sc1 lds
s_add_u32 m0, s60, 15360
s_nop 0
buffer_load_dwordx4 v11, s[28:31], s73 offen sc1 lds
s_add_u32 m0, s60, 15360
s_nop 0
buffer_load_dwordx4 v11, s[28:31], s73 offen offset:1024 sc1 lds
s_mov_b32 s37, 100000
ct_13:
s_waitcnt lgkmcnt(0)
s_cmp_eq_u32 s36, 12
s_cbranch_scc1 ct_14
s_sleep 2
s_load_dword s36, s[22:23], s38 glc
s_sub_u32 s37, s37, 1
s_cbranch_scc0 ct_13
s_waitcnt lgkmcnt(0)
ct_14:
buffer_load_dwordx4 v[196:199], v10, s[28:31], s65 offen offset:0 sc1
buffer_load_dwordx4 v[200:203], v10, s[28:31], s65 offen offset:1024 sc1
buffer_load_dwordx4 v[204:207], v10, s[28:31], s65 offen offset:2048 sc1
buffer_load_dwordx4 v[208:211], v10, s[28:31], s65 offen offset:3072 sc1
buffer_load_dwordx4 v[212:215], v10, s[28:31], s66 offen offset:0 sc1
buffer_load_dwordx4 v[216:219], v10, s[28:31], s66 offen offset:1024 sc1
buffer_load_dwordx4 v[220:223], v10, s[28:31], s66 offen offset:2048 sc1
buffer_load_dwordx4 v[224:227], v10, s[28:31], s66 offen offset:3072 sc1
buffer_load_dwordx4 v[228:231], v10, s[28:31], s67 offen offset:0 sc1
buffer_load_dwordx4 v[232:235], v10, s[28:31], s67 offen offset:1024 sc1
buffer_load_dwordx4 v[236:239], v10, s[28:31], s67 offen offset:2048 sc1
buffer_load_dwordx4 v[240:243], v10, s[28:31], s67 offen offset:3072 sc1
s_waitcnt vmcnt(11)
v_mfma_f32_16x16x32_bf16 v[116:119], v[16:19], v[196:199], 0
v_mfma_f32_16x16x32_bf16 v[120:123], v[20:23], v[196:199], 0
s_add_u32 m0, s60, 15360
s_nop 0
buffer_load_dwordx4 v11, s[28:31], s73 offen offset:2048 sc1 lds
v_mfma_f32_16x16x32_bf16 v[124:127], v[24:27], v[196:199], 0
v_mfma_f32_16x16x32_bf16 v[128:131], v[28:31], v[196:199], 0
v_mfma_f32_16x16x32_bf16 v[132:135], v[32:35], v[196:199], 0
buffer_load_dwordx4 v[196:199], v10, s[28:31], s68 offen offset:0 sc1
s_waitcnt vmcnt(12)
v_mfma_f32_16x16x32_bf16 v[152:155], v[32:35], v[200:203], 0
v_mfma_f32_16x16x32_bf16 v[148:151], v[28:31], v[200:203], 0
s_add_u32 m0, s60, 15360
s_nop 0
buffer_load_dwordx4 v11, s[28:31], s73 offen offset:3072 sc1 lds
v_mfma_f32_16x16x32_bf16 v[144:147], v[24:27], v[200:203], 0
v_mfma_f32_16x16x32_bf16 v[140:143], v[20:23], v[200:203], 0
v_mfma_f32_16x16x32_bf16 v[136:139], v[16:19], v[200:203], 0
buffer_load_dwordx4 v[200:203], v10, s[28:31], s68 offen offset:1024 sc1
s_waitcnt vmcnt(13)
v_mfma_f32_16x16x32_bf16 v[156:159], v[16:19], v[204:207], 0
v_mfma_f32_16x16x32_bf16 v[160:163], v[20:23], v[204:207], 0
s_add_u32 m0, s60, 19456
s_nop 0
buffer_load_dwordx4 v12, s[28:31], s73 offen sc1 lds
v_mfma_f32_16x16x32_bf16 v[164:167], v[24:27], v[204:207], 0
v_mfma_f32_16x16x32_bf16 v[168:171], v[28:31], v[204:207], 0
v_mfma_f32_16x16x32_bf16 v[172:175], v[32:35], v[204:207], 0
buffer_load_dwordx4 v[204:207], v10, s[28:31], s68 offen offset:2048 sc1
s_waitcnt vmcnt(14)
v_mfma_f32_16x16x32_bf16 v[192:195], v[32:35], v[208:211], 0
v_mfma_f32_16x16x32_bf16 v[188:191], v[28:31], v[208:211], 0
v_mfma_f32_16x16x32_bf16 v[184:187], v[24:27], v[208:211], 0
v_mfma_f32_16x16x32_bf16 v[180:183], v[20:23], v[208:211], 0
v_mfma_f32_16x16x32_bf16 v[176:179], v[16:19], v[208:211], 0
buffer_load_dwordx4 v[208:211], v10, s[28:31], s68 offen offset:3072 sc1
s_lshl_b32 s38, s50, 8
s_add_u32 s38, s38, 18874752
s_load_dword s36, s[22:23], s38 glc
s_waitcnt vmcnt(14)
v_mfma_f32_16x16x32_bf16 v[116:119], v[36:39], v[212:215], v[116:119]
v_mfma_f32_16x16x32_bf16 v[120:123], v[40:43], v[212:215], v[120:123]
buffer_load_dwordx4 v[16:19], v11, s[28:31], s74 offen offset:0 sc1
v_mfma_f32_16x16x32_bf16 v[124:127], v[44:47], v[212:215], v[124:127]
v_mfma_f32_16x16x32_bf16 v[128:131], v[48:51], v[212:215], v[128:131]
v_mfma_f32_16x16x32_bf16 v[132:135], v[52:55], v[212:215], v[132:135]
buffer_load_dwordx4 v[212:215], v10, s[28:31], s69 offen offset:0 sc1
s_waitcnt vmcnt(15)
v_mfma_f32_16x16x32_bf16 v[152:155], v[52:55], v[216:219], v[152:155]
v_mfma_f32_16x16x32_bf16 v[148:151], v[48:51], v[216:219], v[148:151]
buffer_load_dwordx4 v[20:23], v11, s[28:31], s74 offen offset:1024 sc1
v_mfma_f32_16x16x32_bf16 v[144:147], v[44:47], v[216:219], v[144:147]
v_mfma_f32_16x16x32_bf16 v[140:143], v[40:43], v[216:219], v[140:143]
v_mfma_f32_16x16x32_bf16 v[136:139], v[36:39], v[216:219], v[136:139]
buffer_load_dwordx4 v[216:219], v10, s[28:31], s69 offen offset:1024 sc1
s_waitcnt vmcnt(16)
v_mfma_f32_16x16x32_bf16 v[156:159], v[36:39], v[220:223], v[156:159]
v_mfma_f32_16x16x32_bf16 v[160:163], v[40:43], v[220:223], v[160:163]
buffer_load_dwordx4 v[24:27], v11, s[28:31], s74 offen offset:2048 sc1
v_mfma_f32_16x16x32_bf16 v[164:167], v[44:47], v[220:223], v[164:167]
v_mfma_f32_16x16x32_bf16 v[168:171], v[48:51], v[220:223], v[168:171]
v_mfma_f32_16x16x32_bf16 v[172:175], v[52:55], v[220:223], v[172:175]
buffer_load_dwordx4 v[220:223], v10, s[28:31], s69 offen offset:2048 sc1
s_waitcnt vmcnt(17)
v_mfma_f32_16x16x32_bf16 v[192:195], v[52:55], v[224:227], v[192:195]
v_mfma_f32_16x16x32_bf16 v[188:191], v[48:51], v[224:227], v[188:191]
v_mfma_f32_16x16x32_bf16 v[184:187], v[44:47], v[224:227], v[184:187]
v_mfma_f32_16x16x32_bf16 v[180:183], v[40:43], v[224:227], v[180:183]
v_mfma_f32_16x16x32_bf16 v[176:179], v[36:39], v[224:227], v[176:179]
buffer_load_dwordx4 v[224:227], v10, s[28:31], s69 offen offset:3072 sc1
s_waitcnt vmcnt(17)
v_mfma_f32_16x16x32_bf16 v[116:119], v[56:59], v[228:231], v[116:119]
v_mfma_f32_16x16x32_bf16 v[120:123], v[60:63], v[228:231], v[120:123]
buffer_load_dwordx4 v[28:31], v11, s[28:31], s74 offen offset:3072 sc1
v_mfma_f32_16x16x32_bf16 v[124:127], v[64:67], v[228:231], v[124:127]
v_mfma_f32_16x16x32_bf16 v[128:131], v[68:71], v[228:231], v[128:131]
v_mfma_f32_16x16x32_bf16 v[132:135], v[72:75], v[228:231], v[132:135]
buffer_load_dwordx4 v[228:231], v10, s[28:31], s70 offen offset:0 sc1
s_waitcnt vmcnt(18)
v_mfma_f32_16x16x32_bf16 v[152:155], v[72:75], v[232:235], v[152:155]
v_mfma_f32_16x16x32_bf16 v[148:151], v[68:71], v[232:235], v[148:151]
buffer_load_dwordx4 v[32:35], v12, s[28:31], s74 offen offset:0 sc1
v_mfma_f32_16x16x32_bf16 v[144:147], v[64:67], v[232:235], v[144:147]
v_mfma_f32_16x16x32_bf16 v[140:143], v[60:63], v[232:235], v[140:143]
v_mfma_f32_16x16x32_bf16 v[136:139], v[56:59], v[232:235], v[136:139]
buffer_load_dwordx4 v[232:235], v10, s[28:31], s70 offen offset:1024 sc1
s_waitcnt vmcnt(19)
v_mfma_f32_16x16x32_bf16 v[156:159], v[56:59], v[236:239], v[156:159]
v_mfma_f32_16x16x32_bf16 v[160:163], v[60:63], v[236:239], v[160:163]
buffer_load_dwordx4 v[36:39], v11, s[28:31], s75 offen offset:0 sc1
v_mfma_f32_16x16x32_bf16 v[164:167], v[64:67], v[236:239], v[164:167]
v_mfma_f32_16x16x32_bf16 v[168:171], v[68:71], v[236:239], v[168:171]
v_mfma_f32_16x16x32_bf16 v[172:175], v[72:75], v[236:239], v[172:175]
buffer_load_dwordx4 v[236:239], v10, s[28:31], s70 offen offset:2048 sc1
s_waitcnt vmcnt(20)
v_mfma_f32_16x16x32_bf16 v[192:195], v[72:75], v[240:243], v[192:195]
v_mfma_f32_16x16x32_bf16 v[188:191], v[68:71], v[240:243], v[188:191]
v_mfma_f32_16x16x32_bf16 v[184:187], v[64:67], v[240:243], v[184:187]
v_mfma_f32_16x16x32_bf16 v[180:183], v[60:63], v[240:243], v[180:183]
v_mfma_f32_16x16x32_bf16 v[176:179], v[56:59], v[240:243], v[176:179]
buffer_load_dwordx4 v[240:243], v10, s[28:31], s70 offen offset:3072 sc1
s_mov_b32 s37, 100000
ct_15:
s_waitcnt lgkmcnt(0)
s_cmp_eq_u32 s36, 12
s_cbranch_scc1 ct_16
s_sleep 2
s_load_dword s36, s[22:23], s38 glc
s_sub_u32 s37, s37, 1
s_cbranch_scc0 ct_15
s_waitcnt lgkmcnt(0)
ct_16:
s_waitcnt vmcnt(19)
v_mfma_f32_16x16x32_bf16 v[116:119], v[76:79], v[196:199], v[116:119]
v_mfma_f32_16x16x32_bf16 v[120:123], v[80:83], v[196:199], v[120:123]
buffer_load_dwordx4 v[40:43], v11, s[28:31], s75 offen offset:1024 sc1
v_mfma_f32_16x16x32_bf16 v[124:127], v[84:87], v[196:199], v[124:127]
v_mfma_f32_16x16x32_bf16 v[128:131], v[88:91], v[196:199], v[128:131]
v_mfma_f32_16x16x32_bf16 v[132:135], v[92:95], v[196:199], v[132:135]
buffer_load_dwordx4 v[196:199], v10, s[28:31], s71 offen offset:0 sc1
s_waitcnt vmcnt(19)
v_mfma_f32_16x16x32_bf16 v[152:155], v[92:95], v[200:203], v[152:155]
v_mfma_f32_16x16x32_bf16 v[148:151], v[88:91], v[200:203], v[148:151]
buffer_load_dwordx4 v[44:47], v11, s[28:31], s75 offen offset:2048 sc1
v_mfma_f32_16x16x32_bf16 v[144:147], v[84:87], v[200:203], v[144:147]
v_mfma_f32_16x16x32_bf16 v[140:143], v[80:83], v[200:203], v[140:143]
v_mfma_f32_16x16x32_bf16 v[136:139], v[76:79], v[200:203], v[136:139]
buffer_load_dwordx4 v[200:203], v10, s[28:31], s71 offen offset:1024 sc1
s_waitcnt vmcnt(19)
v_mfma_f32_16x16x32_bf16 v[156:159], v[76:79], v[204:207], v[156:159]
v_mfma_f32_16x16x32_bf16 v[160:163], v[80:83], v[204:207], v[160:163]
buffer_load_dwordx4 v[48:51], v11, s[28:31], s75 offen offset:3072 sc1
v_mfma_f32_16x16x32_bf16 v[164:167], v[84:87], v[204:207], v[164:167]
v_mfma_f32_16x16x32_bf16 v[168:171], v[88:91], v[204:207], v[168:171]
v_mfma_f32_16x16x32_bf16 v[172:175], v[92:95], v[204:207], v[172:175]
buffer_load_dwordx4 v[204:207], v10, s[28:31], s71 offen offset:2048 sc1
s_waitcnt vmcnt(20)
v_mfma_f32_16x16x32_bf16 v[192:195], v[92:95], v[208:211], v[192:195]
v_mfma_f32_16x16x32_bf16 v[188:191], v[88:91], v[208:211], v[188:191]
v_mfma_f32_16x16x32_bf16 v[184:187], v[84:87], v[208:211], v[184:187]
v_mfma_f32_16x16x32_bf16 v[180:183], v[80:83], v[208:211], v[180:183]
v_mfma_f32_16x16x32_bf16 v[176:179], v[76:79], v[208:211], v[176:179]
buffer_load_dwordx4 v[208:211], v10, s[28:31], s71 offen offset:3072 sc1
s_waitcnt vmcnt(19)
v_mfma_f32_16x16x32_bf16 v[116:119], v[96:99], v[212:215], v[116:119]
ds_read_b128 v[76:79], v244 offset:0
v_mfma_f32_16x16x32_bf16 v[120:123], v[100:103], v[212:215], v[120:123]
ds_read_b128 v[80:83], v244 offset:1024
buffer_load_dwordx4 v[52:55], v12, s[28:31], s75 offen offset:0 sc1
v_mfma_f32_16x16x32_bf16 v[124:127], v[104:107], v[212:215], v[124:127]
ds_read_b128 v[84:87], v244 offset:2048
v_mfma_f32_16x16x32_bf16 v[128:131], v[108:111], v[212:215], v[128:131]
ds_read_b128 v[88:91], v244 offset:3072
v_mfma_f32_16x16x32_bf16 v[132:135], v[112:115], v[212:215], v[132:135]
ds_read_b128 v[92:95], v244 offset:4096
buffer_load_dwordx4 v[212:215], v10, s[28:31], s72 offen offset:0 sc1
s_waitcnt vmcnt(19)
v_mfma_f32_16x16x32_bf16 v[152:155], v[112:115], v[216:219], v[152:155]
v_mfma_f32_16x16x32_bf16 v[148:151], v[108:111], v[216:219], v[148:151]
buffer_load_dwordx4 v[56:59], v11, s[28:31], s76 offen offset:0 sc1
v_mfma_f32_16x16x32_bf16 v[144:147], v[104:107], v[216:219], v[144:147]
v_mfma_f32_16x16x32_bf16 v[140:143], v[100:103], v[216:219], v[140:143]
v_mfma_f32_16x16x32_bf16 v[136:139], v[96:99], v[216:219], v[136:139]
buffer_load_dwordx4 v[216:219], v10, s[28:31], s72 offen offset:1024 sc1
s_waitcnt vmcnt(19)
v_mfma_f32_16x16x32_bf16 v[156:159], v[96:99], v[220:223], v[156:159]
v_mfma_f32_16x16x32_bf16 v[160:163], v[100:103], v[220:223], v[160:163]
buffer_load_dwordx4 v[60:63], v11, s[28:31], s76 offen offset:1024 sc1
v_mfma_f32_16x16x32_bf16 v[164:167], v[104:107], v[220:223], v[164:167]
v_mfma_f32_16x16x32_bf16 v[168:171], v[108:111], v[220:223], v[168:171]
v_mfma_f32_16x16x32_bf16 v[172:175], v[112:115], v[220:223], v[172:175]
buffer_load_dwordx4 v[220:223], v10, s[28:31], s72 offen offset:2048 sc1
s_waitcnt vmcnt(20)
v_mfma_f32_16x16x32_bf16 v[192:195], v[112:115], v[224:227], v[192:195]
v_mfma_f32_16x16x32_bf16 v[188:191], v[108:111], v[224:227], v[188:191]
v_mfma_f32_16x16x32_bf16 v[184:187], v[104:107], v[224:227], v[184:187]
v_mfma_f32_16x16x32_bf16 v[180:183], v[100:103], v[224:227], v[180:183]
v_mfma_f32_16x16x32_bf16 v[176:179], v[96:99], v[224:227], v[176:179]
buffer_load_dwordx4 v[224:227], v10, s[28:31], s72 offen offset:3072 sc1
s_waitcnt lgkmcnt(0)
s_waitcnt vmcnt(19)
v_mfma_f32_16x16x32_bf16 v[116:119], v[76:79], v[228:231], v[116:119]
ds_read_b128 v[96:99], v244 offset:5120
v_mfma_f32_16x16x32_bf16 v[120:123], v[80:83], v[228:231], v[120:123]
ds_read_b128 v[100:103], v244 offset:6144
buffer_load_dwordx4 v[64:67], v11, s[28:31], s76 offen offset:2048 sc1
v_mfma_f32_16x16x32_bf16 v[124:127], v[84:87], v[228:231], v[124:127]
ds_read_b128 v[104:107], v244 offset:7168
v_mfma_f32_16x16x32_bf16 v[128:131], v[88:91], v[228:231], v[128:131]
ds_read_b128 v[108:111], v244 offset:8192
v_mfma_f32_16x16x32_bf16 v[132:135], v[92:95], v[228:231], v[132:135]
ds_read_b128 v[112:115], v244 offset:9216
buffer_load_dwordx4 v[228:231], v10, s[28:31], s73 offen offset:0 sc1
s_waitcnt vmcnt(19)
v_mfma_f32_16x16x32_bf16 v[152:155], v[92:95], v[232:235], v[152:155]
v_mfma_f32_16x16x32_bf16 v[148:151], v[88:91], v[232:235], v[148:151]
buffer_load_dwordx4 v[68:71], v11, s[28:31], s76 offen offset:3072 sc1
v_mfma_f32_16x16x32_bf16 v[144:147], v[84:87], v[232:235], v[144:147]
v_mfma_f32_16x16x32_bf16 v[140:143], v[80:83], v[232:235], v[140:143]
v_mfma_f32_16x16x32_bf16 v[136:139], v[76:79], v[232:235], v[136:139]
buffer_load_dwordx4 v[232:235], v10, s[28:31], s73 offen offset:1024 sc1
s_waitcnt vmcnt(19)
v_mfma_f32_16x16x32_bf16 v[156:159], v[76:79], v[236:239], v[156:159]
v_mfma_f32_16x16x32_bf16 v[160:163], v[80:83], v[236:239], v[160:163]
buffer_load_dwordx4 v[72:75], v12, s[28:31], s76 offen offset:0 sc1
v_mfma_f32_16x16x32_bf16 v[164:167], v[84:87], v[236:239], v[164:167]
v_mfma_f32_16x16x32_bf16 v[168:171], v[88:91], v[236:239], v[168:171]
v_mfma_f32_16x16x32_bf16 v[172:175], v[92:95], v[236:239], v[172:175]
buffer_load_dwordx4 v[236:239], v10, s[28:31], s73 offen offset:2048 sc1
s_waitcnt vmcnt(20)
v_mfma_f32_16x16x32_bf16 v[192:195], v[92:95], v[240:243], v[192:195]
v_mfma_f32_16x16x32_bf16 v[188:191], v[88:91], v[240:243], v[188:191]
v_mfma_f32_16x16x32_bf16 v[184:187], v[84:87], v[240:243], v[184:187]
v_mfma_f32_16x16x32_bf16 v[180:183], v[80:83], v[240:243], v[180:183]
v_mfma_f32_16x16x32_bf16 v[176:179], v[76:79], v[240:243], v[176:179]
buffer_load_dwordx4 v[240:243], v10, s[28:31], s73 offen offset:3072 sc1
s_waitcnt lgkmcnt(0)
s_waitcnt vmcnt(19)
v_mfma_f32_16x16x32_bf16 v[116:119], v[96:99], v[196:199], v[116:119]
ds_read_b128 v[76:79], v244 offset:10240
v_mfma_f32_16x16x32_bf16 v[120:123], v[100:103], v[196:199], v[120:123]
ds_read_b128 v[80:83], v244 offset:11264
v_mfma_f32_16x16x32_bf16 v[124:127], v[104:107], v[196:199], v[124:127]
ds_read_b128 v[84:87], v244 offset:12288
v_mfma_f32_16x16x32_bf16 v[128:131], v[108:111], v[196:199], v[128:131]
ds_read_b128 v[88:91], v244 offset:13312
v_mfma_f32_16x16x32_bf16 v[132:135], v[112:115], v[196:199], v[132:135]
ds_read_b128 v[92:95], v244 offset:14336
buffer_load_dwordx4 v[196:199], v10, s[28:31], s74 offen offset:0 sc1
s_waitcnt vmcnt(18)
v_mfma_f32_16x16x32_bf16 v[152:155], v[112:115], v[200:203], v[152:155]
v_mfma_f32_16x16x32_bf16 v[148:151], v[108:111], v[200:203], v[148:151]
v_mfma_f32_16x16x32_bf16 v[144:147], v[104:107], v[200:203], v[144:147]
v_mfma_f32_16x16x32_bf16 v[140:143], v[100:103], v[200:203], v[140:143]
v_mfma_f32_16x16x32_bf16 v[136:139], v[96:99], v[200:203], v[136:139]
buffer_load_dwordx4 v[200:203], v10, s[28:31], s75 offen offset:0 sc1
s_waitcnt vmcnt(17)
v_mfma_f32_16x16x32_bf16 v[156:159], v[96:99], v[204:207], v[156:159]
v_mfma_f32_16x16x32_bf16 v[160:163], v[100:103], v[204:207], v[160:163]
v_mfma_f32_16x16x32_bf16 v[164:167], v[104:107], v[204:207], v[164:167]
v_mfma_f32_16x16x32_bf16 v[168:171], v[108:111], v[204:207], v[168:171]
v_mfma_f32_16x16x32_bf16 v[172:175], v[112:115], v[204:207], v[172:175]
buffer_load_dwordx4 v[204:207], v10, s[28:31], s76 offen offset:0 sc1
s_waitcnt vmcnt(17)
v_mfma_f32_16x16x32_bf16 v[192:195], v[112:115], v[208:211], v[192:195]
v_mfma_f32_16x16x32_bf16 v[188:191], v[108:111], v[208:211], v[188:191]
v_mfma_f32_16x16x32_bf16 v[184:187], v[104:107], v[208:211], v[184:187]
v_mfma_f32_16x16x32_bf16 v[180:183], v[100:103], v[208:211], v[180:183]
v_mfma_f32_16x16x32_bf16 v[176:179], v[96:99], v[208:211], v[176:179]
buffer_load_dwordx4 v[208:211], v10, s[28:31], s74 offen offset:1024 sc1
s_waitcnt lgkmcnt(0)
s_waitcnt vmcnt(16)
v_mfma_f32_16x16x32_bf16 v[116:119], v[76:79], v[212:215], v[116:119]
ds_read_b128 v[96:99], v244 offset:15360
v_mfma_f32_16x16x32_bf16 v[120:123], v[80:83], v[212:215], v[120:123]
ds_read_b128 v[100:103], v244 offset:16384
v_mfma_f32_16x16x32_bf16 v[124:127], v[84:87], v[212:215], v[124:127]
ds_read_b128 v[104:107], v244 offset:17408
v_mfma_f32_16x16x32_bf16 v[128:131], v[88:91], v[212:215], v[128:131]
ds_read_b128 v[108:111], v244 offset:18432
v_mfma_f32_16x16x32_bf16 v[132:135], v[92:95], v[212:215], v[132:135]
ds_read_b128 v[112:115], v244 offset:19456
buffer_load_dwordx4 v[212:215], v10, s[28:31], s75 offen offset:1024 sc1
s_waitcnt vmcnt(15)
v_mfma_f32_16x16x32_bf16 v[152:155], v[92:95], v[216:219], v[152:155]
v_mfma_f32_16x16x32_bf16 v[148:151], v[88:91], v[216:219], v[148:151]
v_mfma_f32_16x16x32_bf16 v[144:147], v[84:87], v[216:219], v[144:147]
v_mfma_f32_16x16x32_bf16 v[140:143], v[80:83], v[216:219], v[140:143]
v_mfma_f32_16x16x32_bf16 v[136:139], v[76:79], v[216:219], v[136:139]
buffer_load_dwordx4 v[216:219], v10, s[28:31], s76 offen offset:1024 sc1
s_waitcnt vmcnt(14)
v_mfma_f32_16x16x32_bf16 v[156:159], v[76:79], v[220:223], v[156:159]
v_mfma_f32_16x16x32_bf16 v[160:163], v[80:83], v[220:223], v[160:163]
v_mfma_f32_16x16x32_bf16 v[164:167], v[84:87], v[220:223], v[164:167]
v_mfma_f32_16x16x32_bf16 v[168:171], v[88:91], v[220:223], v[168:171]
v_mfma_f32_16x16x32_bf16 v[172:175], v[92:95], v[220:223], v[172:175]
buffer_load_dwordx4 v[220:223], v10, s[28:31], s74 offen offset:2048 sc1
s_waitcnt vmcnt(14)
v_mfma_f32_16x16x32_bf16 v[192:195], v[92:95], v[224:227], v[192:195]
v_mfma_f32_16x16x32_bf16 v[188:191], v[88:91], v[224:227], v[188:191]
v_mfma_f32_16x16x32_bf16 v[184:187], v[84:87], v[224:227], v[184:187]
v_mfma_f32_16x16x32_bf16 v[180:183], v[80:83], v[224:227], v[180:183]
v_mfma_f32_16x16x32_bf16 v[176:179], v[76:79], v[224:227], v[176:179]
buffer_load_dwordx4 v[224:227], v10, s[28:31], s75 offen offset:2048 sc1
s_waitcnt lgkmcnt(0)
s_waitcnt vmcnt(13)
v_mfma_f32_16x16x32_bf16 v[116:119], v[96:99], v[228:231], v[116:119]
v_mfma_f32_16x16x32_bf16 v[120:123], v[100:103], v[228:231], v[120:123]
v_mfma_f32_16x16x32_bf16 v[124:127], v[104:107], v[228:231], v[124:127]
v_mfma_f32_16x16x32_bf16 v[128:131], v[108:111], v[228:231], v[128:131]
v_mfma_f32_16x16x32_bf16 v[132:135], v[112:115], v[228:231], v[132:135]
buffer_load_dwordx4 v[228:231], v10, s[28:31], s76 offen offset:2048 sc1
s_waitcnt vmcnt(12)
v_mfma_f32_16x16x32_bf16 v[152:155], v[112:115], v[232:235], v[152:155]
v_mfma_f32_16x16x32_bf16 v[148:151], v[108:111], v[232:235], v[148:151]
v_mfma_f32_16x16x32_bf16 v[144:147], v[104:107], v[232:235], v[144:147]
v_mfma_f32_16x16x32_bf16 v[140:143], v[100:103], v[232:235], v[140:143]
v_mfma_f32_16x16x32_bf16 v[136:139], v[96:99], v[232:235], v[136:139]
buffer_load_dwordx4 v[232:235], v10, s[28:31], s74 offen offset:3072 sc1
s_waitcnt vmcnt(11)
v_mfma_f32_16x16x32_bf16 v[156:159], v[96:99], v[236:239], v[156:159]
v_mfma_f32_16x16x32_bf16 v[160:163], v[100:103], v[236:239], v[160:163]
v_mfma_f32_16x16x32_bf16 v[164:167], v[104:107], v[236:239], v[164:167]
v_mfma_f32_16x16x32_bf16 v[168:171], v[108:111], v[236:239], v[168:171]
v_mfma_f32_16x16x32_bf16 v[172:175], v[112:115], v[236:239], v[172:175]
buffer_load_dwordx4 v[236:239], v10, s[28:31], s75 offen offset:3072 sc1
s_waitcnt vmcnt(11)
v_mfma_f32_16x16x32_bf16 v[192:195], v[112:115], v[240:243], v[192:195]
v_mfma_f32_16x16x32_bf16 v[188:191], v[108:111], v[240:243], v[188:191]
v_mfma_f32_16x16x32_bf16 v[184:187], v[104:107], v[240:243], v[184:187]
v_mfma_f32_16x16x32_bf16 v[180:183], v[100:103], v[240:243], v[180:183]
v_mfma_f32_16x16x32_bf16 v[176:179], v[96:99], v[240:243], v[176:179]
buffer_load_dwordx4 v[240:243], v10, s[28:31], s76 offen offset:3072 sc1
buffer_load_dwordx4 v[76:79], v251, s[40:43], s53 offen
buffer_load_dwordx4 v[80:83], v251, s[40:43], s51 offen
buffer_load_dwordx2 v[84:85], v252, s[40:43], s56 offen offset:1024
s_waitcnt vmcnt(14)
v_mfma_f32_16x16x32_bf16 v[116:119], v[16:19], v[196:199], v[116:119]
v_mfma_f32_16x16x32_bf16 v[120:123], v[20:23], v[196:199], v[120:123]
v_mfma_f32_16x16x32_bf16 v[124:127], v[24:27], v[196:199], v[124:127]
v_mfma_f32_16x16x32_bf16 v[128:131], v[28:31], v[196:199], v[128:131]
v_mfma_f32_16x16x32_bf16 v[132:135], v[32:35], v[196:199], v[132:135]
s_waitcnt vmcnt(13)
v_mfma_f32_16x16x32_bf16 v[116:119], v[36:39], v[200:203], v[116:119]
v_mfma_f32_16x16x32_bf16 v[120:123], v[40:43], v[200:203], v[120:123]
v_mfma_f32_16x16x32_bf16 v[124:127], v[44:47], v[200:203], v[124:127]
v_mfma_f32_16x16x32_bf16 v[128:131], v[48:51], v[200:203], v[128:131]
v_mfma_f32_16x16x32_bf16 v[132:135], v[52:55], v[200:203], v[132:135]
s_waitcnt vmcnt(12)
v_mfma_f32_16x16x32_bf16 v[116:119], v[56:59], v[204:207], v[116:119]
v_mfma_f32_16x16x32_bf16 v[120:123], v[60:63], v[204:207], v[120:123]
v_mfma_f32_16x16x32_bf16 v[124:127], v[64:67], v[204:207], v[124:127]
v_mfma_f32_16x16x32_bf16 v[128:131], v[68:71], v[204:207], v[128:131]
v_mfma_f32_16x16x32_bf16 v[132:135], v[72:75], v[204:207], v[132:135]
s_lshl_b32 s38, s55, 8
s_add_u32 s38, s38, 18874432
s_load_dword s36, s[22:23], s38 glc
s_waitcnt vmcnt(11)
v_mfma_f32_16x16x32_bf16 v[136:139], v[16:19], v[208:211], v[136:139]
v_mfma_f32_16x16x32_bf16 v[140:143], v[20:23], v[208:211], v[140:143]
v_mfma_f32_16x16x32_bf16 v[144:147], v[24:27], v[208:211], v[144:147]
v_mfma_f32_16x16x32_bf16 v[148:151], v[28:31], v[208:211], v[148:151]
v_mfma_f32_16x16x32_bf16 v[152:155], v[32:35], v[208:211], v[152:155]
ds_write_b128 v245, v[116:119] offset:0
s_waitcnt vmcnt(10)
v_mfma_f32_16x16x32_bf16 v[136:139], v[36:39], v[212:215], v[136:139]
v_mfma_f32_16x16x32_bf16 v[140:143], v[40:43], v[212:215], v[140:143]
ds_write_b128 v246, v[120:123] offset:1024
v_mfma_f32_16x16x32_bf16 v[144:147], v[44:47], v[212:215], v[144:147]
v_mfma_f32_16x16x32_bf16 v[148:151], v[48:51], v[212:215], v[148:151]
ds_write_b128 v247, v[124:127] offset:2048
v_mfma_f32_16x16x32_bf16 v[152:155], v[52:55], v[212:215], v[152:155]
s_waitcnt vmcnt(9)
v_mfma_f32_16x16x32_bf16 v[136:139], v[56:59], v[216:219], v[136:139]
ds_write_b128 v248, v[128:131] offset:3072
v_mfma_f32_16x16x32_bf16 v[140:143], v[60:63], v[216:219], v[140:143]
v_mfma_f32_16x16x32_bf16 v[144:147], v[64:67], v[216:219], v[144:147]
ds_write_b128 v245, v[132:135] offset:4096
v_mfma_f32_16x16x32_bf16 v[148:151], v[68:71], v[216:219], v[148:151]
v_mfma_f32_16x16x32_bf16 v[152:155], v[72:75], v[216:219], v[152:155]
s_waitcnt vmcnt(8)
v_mfma_f32_16x16x32_bf16 v[156:159], v[16:19], v[220:223], v[156:159]
v_mfma_f32_16x16x32_bf16 v[160:163], v[20:23], v[220:223], v[160:163]
v_mfma_f32_16x16x32_bf16 v[164:167], v[24:27], v[220:223], v[164:167]
v_mfma_f32_16x16x32_bf16 v[168:171], v[28:31], v[220:223], v[168:171]
v_mfma_f32_16x16x32_bf16 v[172:175], v[32:35], v[220:223], v[172:175]
ds_write_b128 v245, v[136:139] offset:5120
s_waitcnt vmcnt(7)
v_mfma_f32_16x16x32_bf16 v[156:159], v[36:39], v[224:227], v[156:159]
v_mfma_f32_16x16x32_bf16 v[160:163], v[40:43], v[224:227], v[160:163]
ds_write_b128 v246, v[140:143] offset:6144
v_mfma_f32_16x16x32_bf16 v[164:167], v[44:47], v[224:227], v[164:167]
v_mfma_f32_16x16x32_bf16 v[168:171], v[48:51], v[224:227], v[168:171]
ds_write_b128 v247, v[144:147] offset:7168
v_mfma_f32_16x16x32_bf16 v[172:175], v[52:55], v[224:227], v[172:175]
s_waitcnt vmcnt(6)
v_mfma_f32_16x16x32_bf16 v[156:159], v[56:59], v[228:231], v[156:159]
ds_write_b128 v248, v[148:151] offset:8192
v_mfma_f32_16x16x32_bf16 v[160:163], v[60:63], v[228:231], v[160:163]
v_mfma_f32_16x16x32_bf16 v[164:167], v[64:67], v[228:231], v[164:167]
ds_write_b128 v245, v[152:155] offset:9216
v_mfma_f32_16x16x32_bf16 v[168:171], v[68:71], v[228:231], v[168:171]
v_mfma_f32_16x16x32_bf16 v[172:175], v[72:75], v[228:231], v[172:175]
s_mov_b32 s37, 100000
ct_17:
s_waitcnt lgkmcnt(0)
s_cmp_eq_u32 s36, 2
s_cbranch_scc1 ct_18
s_sleep 2
s_load_dword s36, s[22:23], s38 glc
s_sub_u32 s37, s37, 1
s_cbranch_scc0 ct_17
s_waitcnt lgkmcnt(0)
ct_18:
s_add_u32 s49, s57, 32768
buffer_load_dwordx4 v[86:89], v253, s[28:31], s57 offen sc1
buffer_load_dwordx4 v[90:93], v253, s[28:31], s49 offen sc1
buffer_load_dwordx2 v[94:95], v254, s[28:31], s54 offen sc1
s_waitcnt vmcnt(8)
v_mfma_f32_16x16x32_bf16 v[176:179], v[16:19], v[232:235], v[176:179]
v_mfma_f32_16x16x32_bf16 v[180:183], v[20:23], v[232:235], v[180:183]
v_mfma_f32_16x16x32_bf16 v[184:187], v[24:27], v[232:235], v[184:187]
v_mfma_f32_16x16x32_bf16 v[188:191], v[28:31], v[232:235], v[188:191]
v_mfma_f32_16x16x32_bf16 v[192:195], v[32:35], v[232:235], v[192:195]
ds_write_b128 v245, v[156:159] offset:10240
s_waitcnt vmcnt(7)
v_mfma_f32_16x16x32_bf16 v[176:179], v[36:39], v[236:239], v[176:179]
v_mfma_f32_16x16x32_bf16 v[180:183], v[40:43], v[236:239], v[180:183]
ds_write_b128 v246, v[160:163] offset:11264
v_mfma_f32_16x16x32_bf16 v[184:187], v[44:47], v[236:239], v[184:187]
v_mfma_f32_16x16x32_bf16 v[188:191], v[48:51], v[236:239], v[188:191]
ds_write_b128 v247, v[164:167] offset:12288
v_mfma_f32_16x16x32_bf16 v[192:195], v[52:55], v[236:239], v[192:195]
s_waitcnt vmcnt(6)
v_mfma_f32_16x16x32_bf16 v[176:179], v[56:59], v[240:243], v[176:179]
ds_write_b128 v248, v[168:171] offset:13312
v_mfma_f32_16x16x32_bf16 v[180:183], v[60:63], v[240:243], v[180:183]
v_mfma_f32_16x16x32_bf16 v[184:187], v[64:67], v[240:243], v[184:187]
ds_write_b128 v245, v[172:175] offset:14336
v_mfma_f32_16x16x32_bf16 v[188:191], v[68:71], v[240:243], v[188:191]
v_mfma_f32_16x16x32_bf16 v[192:195], v[72:75], v[240:243], v[192:195]
v_add_u32 v6, 10240, v249
s_mov_b32 s48, 0xffff0000
v_mov_b32 v8, 0xbfb8aa3b
v_mov_b32 v9, v8
ds_write_b128 v245, v[176:179] offset:15360
ds_write_b128 v246, v[180:183] offset:16384
ds_write_b128 v247, v[184:187] offset:17408
ds_write_b128 v248, v[188:191] offset:18432
ds_write_b128 v245, v[192:195] offset:19456
s_branch S_F
.p2align 12
T_L:
s_branch T_F
S_L:
s_mov_b32 s58, 4
s_waitcnt vmcnt(8)
s_barrier
ds_read_b64_tr_b16 v[212:213], v102 offset:0
ds_read_b64_tr_b16 v[214:215], v102 offset:512
s_add_u32 m0, s60, 16384
ds_read_b64_tr_b16 v[216:217], v103 offset:0
ds_read_b64_tr_b16 v[218:219], v103 offset:512
buffer_load_dwordx4 v96, s[44:47], s56 offen lds
ds_read_b128 v[220:223], v252 offset:0
ds_read_b128 v[224:227], v252 offset:4096
ds_read_b128 v[228:231], v252 offset:8192
ds_read_b128 v[72:75], v254 offset:0
s_add_u32 m0, s60, 17408
ds_read_b128 v[76:79], v254 offset:4096
ds_read_b128 v[80:83], v254 offset:8192
buffer_load_dwordx4 v97, s[44:47], s56 offen lds
s_add_u32 s56, s56, 98304
ds_read_b128 v[84:87], v255 offset:0
ds_read_b128 v[88:91], v255 offset:4096
s_branch L_g1mid
g1loop_3:
s_barrier
v_mfma_f32_32x32x16_bf16 v[116:131], v[232:235], v[84:87], v[116:131]
ds_read_b64_tr_b16 v[212:213], v102 offset:0
ds_read_b64_tr_b16 v[214:215], v102 offset:512
s_add_u32 m0, s60, 16384
v_mfma_f32_32x32x16_bf16 v[164:179], v[236:239], v[84:87], v[164:179]
ds_read_b64_tr_b16 v[216:217], v103 offset:0
ds_read_b64_tr_b16 v[218:219], v103 offset:512
buffer_load_dwordx4 v96, s[44:47], s56 offen lds
v_mfma_f32_32x32x16_bf16 v[132:147], v[232:235], v[88:91], v[132:147]
ds_read_b128 v[220:223], v252 offset:0
ds_read_b128 v[224:227], v252 offset:4096
v_mfma_f32_32x32x16_bf16 v[180:195], v[236:239], v[88:91], v[180:195]
ds_read_b128 v[228:231], v252 offset:8192
ds_read_b128 v[72:75], v254 offset:0
s_add_u32 m0, s60, 17408
v_mfma_f32_32x32x16_bf16 v[148:163], v[232:235], v[92:95], v[148:163]
ds_read_b128 v[76:79], v254 offset:4096
ds_read_b128 v[80:83], v254 offset:8192
buffer_load_dwordx4 v97, s[44:47], s56 offen lds
s_add_u32 s56, s56, 98304
v_mfma_f32_32x32x16_bf16 v[196:211], v[236:239], v[92:95], v[196:211]
ds_read_b128 v[84:87], v255 offset:0
ds_read_b128 v[88:91], v255 offset:4096
L_g1mid:
s_waitcnt lgkmcnt(5)
v_mfma_f32_32x32x16_bf16 v[116:131], v[212:215], v[220:223], v[116:131]
ds_read_b64_tr_b16 v[232:233], v102 offset:2048
ds_read_b64_tr_b16 v[234:235], v102 offset:2560
v_mfma_f32_32x32x16_bf16 v[164:179], v[216:219], v[220:223], v[164:179]
ds_read_b64_tr_b16 v[236:237], v103 offset:2048
ds_read_b64_tr_b16 v[238:239], v103 offset:2560
s_add_u32 m0, s60, 24576
v_mfma_f32_32x32x16_bf16 v[132:147], v[212:215], v[224:227], v[132:147]
ds_read_b128 v[240:243], v253 offset:0
ds_read_b128 v[244:247], v253 offset:4096
buffer_load_dwordx4 v96, s[44:47], s56 offen lds
v_mfma_f32_32x32x16_bf16 v[180:195], v[216:219], v[224:227], v[180:195]
ds_read_b128 v[248:251], v253 offset:8192
ds_read_b128 v[92:95], v255 offset:8192
s_add_u32 m0, s60, 25600
v_mfma_f32_32x32x16_bf16 v[148:163], v[212:215], v[228:231], v[148:163]
buffer_load_dwordx4 v97, s[44:47], s56 offen lds
s_add_u32 s56, s56, 98304
v_mfma_f32_32x32x16_bf16 v[196:211], v[216:219], v[228:231], v[196:211]
s_waitcnt vmcnt(10) lgkmcnt(0)
s_barrier
v_mfma_f32_32x32x16_bf16 v[116:131], v[232:235], v[240:243], v[116:131]
ds_read_b64_tr_b16 v[212:213], v102 offset:8192
ds_read_b64_tr_b16 v[214:215], v102 offset:8704
v_mfma_f32_32x32x16_bf16 v[164:179], v[236:239], v[240:243], v[164:179]
ds_read_b64_tr_b16 v[216:217], v103 offset:8192
ds_read_b64_tr_b16 v[218:219], v103 offset:8704
s_add_u32 m0, s59, 32768
v_mfma_f32_32x32x16_bf16 v[132:147], v[232:235], v[244:247], v[132:147]
buffer_load_dwordx4 v100, s[40:43], s53 offen lds
s_add_u32 m0, s59, 33792
v_mfma_f32_32x32x16_bf16 v[180:195], v[236:239], v[244:247], v[180:195]
buffer_load_dwordx4 v101, s[40:43], s53 offen lds
s_add_u32 s53, s53, 128
v_mfma_f32_32x32x16_bf16 v[148:163], v[232:235], v[248:251], v[148:163]
s_add_u32 m0, s59, 34816
v_mfma_f32_32x32x16_bf16 v[196:211], v[236:239], v[248:251], v[196:211]
buffer_load_dwordx4 v100, s[40:43], s54 offen lds
s_waitcnt lgkmcnt(0)
v_mfma_f32_32x32x16_bf16 v[116:131], v[212:215], v[72:75], v[116:131]
ds_read_b64_tr_b16 v[232:233], v102 offset:10240
ds_read_b64_tr_b16 v[234:235], v102 offset:10752
v_mfma_f32_32x32x16_bf16 v[164:179], v[216:219], v[72:75], v[164:179]
ds_read_b64_tr_b16 v[236:237], v103 offset:10240
ds_read_b64_tr_b16 v[238:239], v103 offset:10752
s_add_u32 m0, s59, 35840
v_mfma_f32_32x32x16_bf16 v[132:147], v[212:215], v[76:79], v[132:147]
buffer_load_dwordx4 v101, s[40:43], s54 offen lds
s_add_u32 s54, s54, 128
s_add_u32 m0, s59, 36864
v_mfma_f32_32x32x16_bf16 v[180:195], v[216:219], v[76:79], v[180:195]
buffer_load_dwordx4 v100, s[40:43], s55 offen lds
v_mfma_f32_32x32x16_bf16 v[148:163], v[212:215], v[80:83], v[148:163]
s_add_u32 m0, s59, 37888
v_mfma_f32_32x32x16_bf16 v[196:211], v[216:219], v[80:83], v[196:211]
buffer_load_dwordx4 v101, s[40:43], s55 offen lds
s_add_u32 s55, s55, 128
s_waitcnt vmcnt(8) lgkmcnt(0)
s_barrier
v_mfma_f32_32x32x16_bf16 v[116:131], v[232:235], v[84:87], v[116:131]
ds_read_b64_tr_b16 v[212:213], v102 offset:16384
ds_read_b64_tr_b16 v[214:215], v102 offset:16896
s_add_u32 m0, s60, 0
v_mfma_f32_32x32x16_bf16 v[164:179], v[236:239], v[84:87], v[164:179]
ds_read_b64_tr_b16 v[216:217], v103 offset:16384
ds_read_b64_tr_b16 v[218:219], v103 offset:16896
buffer_load_dwordx4 v96, s[44:47], s56 offen lds
v_mfma_f32_32x32x16_bf16 v[132:147], v[232:235], v[88:91], v[132:147]
ds_read_b128 v[220:223], v252 offset:24576
ds_read_b128 v[224:227], v252 offset:28672
v_mfma_f32_32x32x16_bf16 v[180:195], v[236:239], v[88:91], v[180:195]
ds_read_b128 v[228:231], v252 offset:32768
ds_read_b128 v[72:75], v254 offset:24576
s_add_u32 m0, s60, 1024
v_mfma_f32_32x32x16_bf16 v[148:163], v[232:235], v[92:95], v[148:163]
ds_read_b128 v[76:79], v254 offset:28672
ds_read_b128 v[80:83], v254 offset:32768
buffer_load_dwordx4 v97, s[44:47], s56 offen lds
s_add_u32 s56, s56, 98304
v_mfma_f32_32x32x16_bf16 v[196:211], v[236:239], v[92:95], v[196:211]
ds_read_b128 v[84:87], v255 offset:24576
ds_read_b128 v[88:91], v255 offset:28672
s_waitcnt lgkmcnt(5)
v_mfma_f32_32x32x16_bf16 v[116:131], v[212:215], v[220:223], v[116:131]
ds_read_b64_tr_b16 v[232:233], v102 offset:18432
ds_read_b64_tr_b16 v[234:235], v102 offset:18944
v_mfma_f32_32x32x16_bf16 v[164:179], v[216:219], v[220:223], v[164:179]
ds_read_b64_tr_b16 v[236:237], v103 offset:18432
ds_read_b64_tr_b16 v[238:239], v103 offset:18944
s_add_u32 m0, s60, 8192
v_mfma_f32_32x32x16_bf16 v[132:147], v[212:215], v[224:227], v[132:147]
ds_read_b128 v[240:243], v253 offset:24576
ds_read_b128 v[244:247], v253 offset:28672
buffer_load_dwordx4 v96, s[44:47], s56 offen lds
v_mfma_f32_32x32x16_bf16 v[180:195], v[216:219], v[224:227], v[180:195]
ds_read_b128 v[248:251], v253 offset:32768
ds_read_b128 v[92:95], v255 offset:32768
s_add_u32 m0, s60, 9216
v_mfma_f32_32x32x16_bf16 v[148:163], v[212:215], v[228:231], v[148:163]
buffer_load_dwordx4 v97, s[44:47], s56 offen lds
s_add_u32 s56, s56, 98304
v_mfma_f32_32x32x16_bf16 v[196:211], v[216:219], v[228:231], v[196:211]
s_waitcnt vmcnt(10) lgkmcnt(0)
s_barrier
v_mfma_f32_32x32x16_bf16 v[116:131], v[232:235], v[240:243], v[116:131]
ds_read_b64_tr_b16 v[212:213], v102 offset:24576
ds_read_b64_tr_b16 v[214:215], v102 offset:25088
v_mfma_f32_32x32x16_bf16 v[164:179], v[236:239], v[240:243], v[164:179]
ds_read_b64_tr_b16 v[216:217], v103 offset:24576
ds_read_b64_tr_b16 v[218:219], v103 offset:25088
s_add_u32 m0, s59, 57344
v_mfma_f32_32x32x16_bf16 v[132:147], v[232:235], v[244:247], v[132:147]
buffer_load_dwordx4 v100, s[40:43], s53 offen lds
s_add_u32 m0, s59, 58368
v_mfma_f32_32x32x16_bf16 v[180:195], v[236:239], v[244:247], v[180:195]
buffer_load_dwordx4 v101, s[40:43], s53 offen lds
s_add_u32 s53, s53, 128
v_mfma_f32_32x32x16_bf16 v[148:163], v[232:235], v[248:251], v[148:163]
s_add_u32 m0, s59, 59392
v_mfma_f32_32x32x16_bf16 v[196:211], v[236:239], v[248:251], v[196:211]
buffer_load_dwordx4 v100, s[40:43], s54 offen lds
s_waitcnt lgkmcnt(0)
v_mfma_f32_32x32x16_bf16 v[116:131], v[212:215], v[72:75], v[116:131]
ds_read_b64_tr_b16 v[232:233], v102 offset:26624
ds_read_b64_tr_b16 v[234:235], v102 offset:27136
v_mfma_f32_32x32x16_bf16 v[164:179], v[216:219], v[72:75], v[164:179]
ds_read_b64_tr_b16 v[236:237], v103 offset:26624
ds_read_b64_tr_b16 v[238:239], v103 offset:27136
s_add_u32 m0, s59, 60416
v_mfma_f32_32x32x16_bf16 v[132:147], v[212:215], v[76:79], v[132:147]
buffer_load_dwordx4 v101, s[40:43], s54 offen lds
s_add_u32 s54, s54, 128
s_add_u32 m0, s59, 61440
v_mfma_f32_32x32x16_bf16 v[180:195], v[216:219], v[76:79], v[180:195]
buffer_load_dwordx4 v100, s[40:43], s55 offen lds
v_mfma_f32_32x32x16_bf16 v[148:163], v[212:215], v[80:83], v[148:163]
s_add_u32 m0, s59, 62464
v_mfma_f32_32x32x16_bf16 v[196:211], v[216:219], v[80:83], v[196:211]
buffer_load_dwordx4 v101, s[40:43], s55 offen lds
s_add_u32 s55, s55, 128
s_sub_u32 s58, s58, 1
s_cmp_lg_u32 s58, 0
s_waitcnt vmcnt(8) lgkmcnt(0)
s_cbranch_scc1 g1loop_3
s_barrier
v_mfma_f32_32x32x16_bf16 v[116:131], v[232:235], v[84:87], v[116:131]
ds_read_b64_tr_b16 v[212:213], v102 offset:0
ds_read_b64_tr_b16 v[214:215], v102 offset:512
s_add_u32 m0, s60, 16384
v_mfma_f32_32x32x16_bf16 v[164:179], v[236:239], v[84:87], v[164:179]
ds_read_b64_tr_b16 v[216:217], v103 offset:0
ds_read_b64_tr_b16 v[218:219], v103 offset:512
buffer_load_dwordx4 v96, s[44:47], s56 offen lds
v_mfma_f32_32x32x16_bf16 v[132:147], v[232:235], v[88:91], v[132:147]
ds_read_b128 v[220:223], v252 offset:0
ds_read_b128 v[224:227], v252 offset:4096
v_mfma_f32_32x32x16_bf16 v[180:195], v[236:239], v[88:91], v[180:195]
ds_read_b128 v[228:231], v252 offset:8192
ds_read_b128 v[72:75], v254 offset:0
s_add_u32 m0, s60, 17408
v_mfma_f32_32x32x16_bf16 v[148:163], v[232:235], v[92:95], v[148:163]
ds_read_b128 v[76:79], v254 offset:4096
ds_read_b128 v[80:83], v254 offset:8192
buffer_load_dwordx4 v97, s[44:47], s56 offen lds
s_add_u32 s56, s56, 98304
v_mfma_f32_32x32x16_bf16 v[196:211], v[236:239], v[92:95], v[196:211]
ds_read_b128 v[84:87], v255 offset:0
ds_read_b128 v[88:91], v255 offset:4096
s_waitcnt lgkmcnt(5)
v_mfma_f32_32x32x16_bf16 v[116:131], v[212:215], v[220:223], v[116:131]
ds_read_b64_tr_b16 v[232:233], v102 offset:2048
ds_read_b64_tr_b16 v[234:235], v102 offset:2560
v_mfma_f32_32x32x16_bf16 v[164:179], v[216:219], v[220:223], v[164:179]
ds_read_b64_tr_b16 v[236:237], v103 offset:2048
ds_read_b64_tr_b16 v[238:239], v103 offset:2560
s_add_u32 m0, s60, 24576
v_mfma_f32_32x32x16_bf16 v[132:147], v[212:215], v[224:227], v[132:147]
ds_read_b128 v[240:243], v253 offset:0
ds_read_b128 v[244:247], v253 offset:4096
buffer_load_dwordx4 v96, s[44:47], s56 offen lds
v_mfma_f32_32x32x16_bf16 v[180:195], v[216:219], v[224:227], v[180:195]
ds_read_b128 v[248:251], v253 offset:8192
ds_read_b128 v[92:95], v255 offset:8192
s_add_u32 m0, s60, 25600
v_mfma_f32_32x32x16_bf16 v[148:163], v[212:215], v[228:231], v[148:163]
buffer_load_dwordx4 v97, s[44:47], s56 offen lds
s_add_u32 s56, s56, 98304
v_mfma_f32_32x32x16_bf16 v[196:211], v[216:219], v[228:231], v[196:211]
s_waitcnt vmcnt(10) lgkmcnt(0)
s_barrier
v_mfma_f32_32x32x16_bf16 v[116:131], v[232:235], v[240:243], v[116:131]
ds_read_b64_tr_b16 v[212:213], v102 offset:8192
ds_read_b64_tr_b16 v[214:215], v102 offset:8704
v_mfma_f32_32x32x16_bf16 v[164:179], v[236:239], v[240:243], v[164:179]
ds_read_b64_tr_b16 v[216:217], v103 offset:8192
ds_read_b64_tr_b16 v[218:219], v103 offset:8704
v_mfma_f32_32x32x16_bf16 v[132:147], v[232:235], v[244:247], v[132:147]
buffer_load_dword v3, off, s[32:35], 0 sc1
s_and_b32 s37, s25, 7
s_lshl_b32 s37, s37, 5
s_lshl_b32 s38, s37, 7
s_add_u32 s38, s38, 19169280
s_mov_b64 exec, 65535
buffer_load_dword v2, v4, s[28:31], s38 offen sc1
s_mov_b64 exec, -1
v_mfma_f32_32x32x16_bf16 v[180:195], v[236:239], v[244:247], v[180:195]
v_mfma_f32_32x32x16_bf16 v[148:163], v[232:235], v[248:251], v[148:163]
v_and_b32 v100, 7, v1
v_and_b32 v6, 24, v1
v_lshl_add_u32 v100, v6, 2, v100
v_lshlrev_b32 v100, 3, v100
s_lshr_b32 s50, s50, 2
s_mul_i32 s48, s62, 3
s_add_u32 s50, s50, s48
s_lshl_b32 s53, s50, 10
s_add_u32 s53, s53, 18874368
v_mfma_f32_32x32x16_bf16 v[196:211], v[236:239], v[248:251], v[196:211]
v_and_b32 v6, 15, v1
v_bfe_u32 v7, v1, 4, 1
v_mul_u32_u24 v9, 1536, v7
v_lshrrev_b32 v8, 5, v1
s_waitcnt lgkmcnt(0)
v_mfma_f32_32x32x16_bf16 v[116:131], v[212:215], v[72:75], v[116:131]
ds_read_b64_tr_b16 v[232:233], v102 offset:10240
ds_read_b64_tr_b16 v[234:235], v102 offset:10752
v_mfma_f32_32x32x16_bf16 v[164:179], v[216:219], v[72:75], v[164:179]
ds_read_b64_tr_b16 v[236:237], v103 offset:10240
ds_read_b64_tr_b16 v[238:239], v103 offset:10752
v_mfma_f32_32x32x16_bf16 v[132:147], v[212:215], v[76:79], v[132:147]
s_movk_i32 s48, 9216
v_mad_u32_u24 v9, v8, s48, v9
v_lshl_add_u32 v9, v6, 1, v9
v_lshlrev_b32 v101, 2, v9
s_lshl_b32 s48, s61, 1
s_add_u32 s48, s51, s48
s_lshl_b32 s56, s48, 6
s_add_u32 s56, s56, 18939904
v_mfma_f32_32x32x16_bf16 v[180:195], v[216:219], v[76:79], v[180:195]
v_mfma_f32_32x32x16_bf16 v[148:163], v[212:215], v[80:83], v[148:163]
v_lshl_add_u32 v7, v7, 2, v8
v_lshl_add_u32 v7, v7, 4, v6
v_lshlrev_b32 v97, 4, v7
v_mov_b32 v114, 0
v_mov_b32 v115, 0
v_mfma_f32_32x32x16_bf16 v[196:211], v[216:219], v[80:83], v[196:211]
s_waitcnt vmcnt(4) lgkmcnt(0)
s_barrier
v_mfma_f32_32x32x16_bf16 v[116:131], v[232:235], v[84:87], v[116:131]
ds_read_b64_tr_b16 v[212:213], v102 offset:16384
ds_read_b64_tr_b16 v[214:215], v102 offset:16896
v_mfma_f32_32x32x16_bf16 v[164:179], v[236:239], v[84:87], v[164:179]
ds_read_b64_tr_b16 v[216:217], v103 offset:16384
ds_read_b64_tr_b16 v[218:219], v103 offset:16896
s_waitcnt vmcnt(0)
v_cmp_ne_u32 vcc, v3, v2
v_readfirstlane_b32 s36, v3
s_nop 0
s_and_b32 s3, vcc_lo, 0xffff
s_cbranch_scc1 slow_4
s_cmp_eq_u32 s36, 0
s_cbranch_scc1 slow_4
ret_5:
v_mfma_f32_32x32x16_bf16 v[132:147], v[232:235], v[88:91], v[132:147]
ds_read_b128 v[220:223], v252 offset:24576
ds_read_b128 v[224:227], v252 offset:28672
buffer_load_dwordx2 v[104:105], v100, s[28:31], s53 offen offset:0 sc1
buffer_load_dwordx2 v[106:107], v100, s[28:31], s53 offen offset:1024 sc1
buffer_load_dwordx2 v[108:109], v100, s[28:31], s53 offen offset:2048 sc1
v_mfma_f32_32x32x16_bf16 v[180:195], v[236:239], v[88:91], v[180:195]
ds_read_b128 v[228:231], v252 offset:32768
ds_read_b128 v[72:75], v254 offset:24576
buffer_load_dwordx2 v[110:111], v101, s[28:31], s56 offen sc1
s_add_u32 s56, s56, 12288
v_mfma_f32_32x32x16_bf16 v[148:163], v[232:235], v[92:95], v[148:163]
ds_read_b128 v[76:79], v254 offset:28672
ds_read_b128 v[80:83], v254 offset:32768
buffer_load_dwordx2 v[112:113], v101, s[28:31], s56 offen sc1
s_add_u32 s56, s56, 12288
v_mfma_f32_32x32x16_bf16 v[196:211], v[236:239], v[92:95], v[196:211]
ds_read_b128 v[84:87], v255 offset:24576
ds_read_b128 v[88:91], v255 offset:28672
s_mov_b32 exec_hi, 0
buffer_load_dwordx2 v[114:115], v101, s[28:31], s56 offen sc1
s_mov_b32 exec_hi, -1
s_waitcnt lgkmcnt(5)
v_mfma_f32_32x32x16_bf16 v[116:131], v[212:215], v[220:223], v[116:131]
ds_read_b64_tr_b16 v[232:233], v102 offset:18432
ds_read_b64_tr_b16 v[234:235], v102 offset:18944
v_mfma_f32_32x32x16_bf16 v[164:179], v[216:219], v[220:223], v[164:179]
ds_read_b64_tr_b16 v[236:237], v103 offset:18432
ds_read_b64_tr_b16 v[238:239], v103 offset:18944
v_mfma_f32_32x32x16_bf16 v[132:147], v[212:215], v[224:227], v[132:147]
ds_read_b128 v[240:243], v253 offset:24576
ds_read_b128 v[244:247], v253 offset:28672
buffer_load_dwordx4 v[16:19], v11, s[28:31], s65 offen offset:0 sc1
v_mfma_f32_32x32x16_bf16 v[180:195], v[216:219], v[224:227], v[180:195]
ds_read_b128 v[248:251], v253 offset:32768
ds_read_b128 v[92:95], v255 offset:32768
buffer_load_dwordx4 v[20:23], v11, s[28:31], s65 offen offset:1024 sc1
v_mfma_f32_32x32x16_bf16 v[148:163], v[212:215], v[228:231], v[148:163]
buffer_load_dwordx4 v[24:27], v11, s[28:31], s65 offen offset:2048 sc1
v_mfma_f32_32x32x16_bf16 v[196:211], v[216:219], v[228:231], v[196:211]
buffer_load_dwordx4 v[28:31], v11, s[28:31], s65 offen offset:3072 sc1
s_waitcnt lgkmcnt(0)
s_barrier
v_mfma_f32_32x32x16_bf16 v[116:131], v[232:235], v[240:243], v[116:131]
ds_read_b64_tr_b16 v[212:213], v102 offset:24576
ds_read_b64_tr_b16 v[214:215], v102 offset:25088
v_mfma_f32_32x32x16_bf16 v[164:179], v[236:239], v[240:243], v[164:179]
ds_read_b64_tr_b16 v[216:217], v103 offset:24576
ds_read_b64_tr_b16 v[218:219], v103 offset:25088
v_mfma_f32_32x32x16_bf16 v[132:147], v[232:235], v[244:247], v[132:147]
buffer_load_dwordx4 v[32:35], v12, s[28:31], s65 offen offset:0 sc1
v_mfma_f32_32x32x16_bf16 v[180:195], v[236:239], v[244:247], v[180:195]
buffer_load_dwordx4 v[36:39], v11, s[28:31], s66 offen offset:0 sc1
v_mfma_f32_32x32x16_bf16 v[148:163], v[232:235], v[248:251], v[148:163]
buffer_load_dwordx4 v[40:43], v11, s[28:31], s66 offen offset:1024 sc1
v_mfma_f32_32x32x16_bf16 v[196:211], v[236:239], v[248:251], v[196:211]
buffer_load_dwordx4 v[44:47], v11, s[28:31], s66 offen offset:2048 sc1
s_waitcnt lgkmcnt(0)
v_mfma_f32_32x32x16_bf16 v[116:131], v[212:215], v[72:75], v[116:131]
ds_read_b64_tr_b16 v[232:233], v102 offset:26624
ds_read_b64_tr_b16 v[234:235], v102 offset:27136
v_mfma_f32_32x32x16_bf16 v[164:179], v[216:219], v[72:75], v[164:179]
ds_read_b64_tr_b16 v[236:237], v103 offset:26624
ds_read_b64_tr_b16 v[238:239], v103 offset:27136
v_mfma_f32_32x32x16_bf16 v[132:147], v[212:215], v[76:79], v[132:147]
buffer_load_dwordx4 v[48:51], v11, s[28:31], s66 offen offset:3072 sc1
v_mfma_f32_32x32x16_bf16 v[180:195], v[216:219], v[76:79], v[180:195]
buffer_load_dwordx4 v[52:55], v12, s[28:31], s66 offen offset:0 sc1
v_mfma_f32_32x32x16_bf16 v[148:163], v[212:215], v[80:83], v[148:163]
buffer_load_dwordx4 v[56:59], v11, s[28:31], s67 offen offset:0 sc1
v_mfma_f32_32x32x16_bf16 v[196:211], v[216:219], v[80:83], v[196:211]
buffer_load_dwordx4 v[60:63], v11, s[28:31], s67 offen offset:1024 sc1
s_waitcnt lgkmcnt(0)
s_barrier
s_mul_i32 s60, s24, 20480
s_waitcnt vmcnt(12)
v_mfma_f32_32x32x16_bf16 v[116:131], v[232:235], v[84:87], v[116:131]
v_cvt_pk_bf16_f32 v220, -v104, -v104
v_mov_b64 v[222:223], 0
v_lshlrev_b32 v6, 16, v220
v_add_f32 v6, v6, v104
v_cvt_pk_bf16_f32 v221, -v6, 0
v_mfma_f32_32x32x16_bf16 v[132:147], v[232:235], v[88:91], v[132:147]
v_cvt_pk_bf16_f32 v224, -v106, -v106
v_mov_b64 v[226:227], 0
v_lshlrev_b32 v6, 16, v224
v_add_f32_e64 v6, v6, v106
v_cvt_pk_bf16_f32 v225, -v6, 0
v_mfma_f32_32x32x16_bf16 v[148:163], v[232:235], v[92:95], v[148:163]
v_cvt_pk_bf16_f32 v228, -v108, -v108
v_mov_b64 v[230:231], 0
v_lshlrev_b32 v6, 16, v228
v_add_f32 v6, v6, v108
v_cvt_pk_bf16_f32 v229, -v6, 0
v_mfma_f32_32x32x16_bf16 v[164:179], v[236:239], v[84:87], v[164:179]
v_add_f32 v110, v110, v112
v_add_f32 v110, v110, v114
v_cvt_pk_bf16_f32 v213, v110, 0
v_mov_b64 v[214:215], 0
v_lshlrev_b32 v7, 16, v213
v_sub_f32 v8, v110, v7
v_cvt_pk_bf16_f32 v212, v7, v8
v_mfma_f32_32x32x16_bf16 v[180:195], v[236:239], v[88:91], v[180:195]
v_add_f32 v111, v111, v113
v_add_f32 v111, v111, v115
v_cvt_pk_bf16_f32 v217, v111, 0
v_mov_b64 v[218:219], 0
v_lshlrev_b32 v7, 16, v217
v_sub_f32 v8, v111, v7
v_cvt_pk_bf16_f32 v216, v7, v8
v_mfma_f32_32x32x16_bf16 v[196:211], v[236:239], v[92:95], v[196:211]
v_mfma_f32_32x32x16_bf16 v[116:131], v[212:215], v[220:223], v[116:131]
v_rsq_f32 v7, v105
s_nop 0
v_mul_f32 v8, v7, v7
v_mul_f32 v110, 0xc0135761, v7
v_mul_f32 v8, 0x3d372713, v8
v_mul_f32 v111, v110, v8
v_mfma_f32_32x32x16_bf16 v[132:147], v[212:215], v[224:227], v[132:147]
v_rsq_f32 v7, v107
s_nop 0
v_mul_f32 v8, v7, v7
v_mul_f32 v112, 0xc0135761, v7
v_mul_f32 v8, 0x3d372713, v8
v_mul_f32 v113, v112, v8
v_mfma_f32_32x32x16_bf16 v[148:163], v[212:215], v[228:231], v[148:163]
v_rsq_f32 v7, v109
s_nop 0
v_mul_f32 v8, v7, v7
v_mul_f32 v114, 0xc0135761, v7
v_mul_f32 v8, 0x3d372713, v8
v_mul_f32 v115, v114, v8
v_mfma_f32_32x32x16_bf16 v[164:179], v[216:219], v[220:223], v[164:179]
s_add_u32 s49, s50, 0
s_and_b32 s48, s49, 1
s_mul_i32 s48, s48, 2048
s_lshr_b32 s49, s49, 1
s_mul_i32 s49, s49, 196608
s_add_u32 s48, s48, s49
s_lshl_b32 s49, s61, 9
s_add_u32 s48, s48, s49
s_mul_i32 s49, s51, 2048
s_add_u32 s48, s48, s49
s_add_u32 s53, s48, 10485760
v_mfma_f32_32x32x16_bf16 v[180:195], v[216:219], v[224:227], v[180:195]
s_add_u32 s49, s50, 1
s_and_b32 s48, s49, 1
s_mul_i32 s48, s48, 2048
s_lshr_b32 s49, s49, 1
s_mul_i32 s49, s49, 196608
s_add_u32 s48, s48, s49
s_lshl_b32 s49, s61, 9
s_add_u32 s48, s48, s49
s_mul_i32 s49, s51, 2048
s_add_u32 s48, s48, s49
s_add_u32 s56, s48, 10485760
v_mfma_f32_32x32x16_bf16 v[196:211], v[216:219], v[228:231], v[196:211]
s_add_u32 s49, s50, 2
s_and_b32 s48, s49, 1
s_mul_i32 s48, s48, 2048
s_lshr_b32 s49, s49, 1
s_mul_i32 s49, s49, 196608
s_add_u32 s48, s48, s49
s_lshl_b32 s49, s61, 9
s_add_u32 s48, s48, s49
s_mul_i32 s49, s51, 2048
s_add_u32 s48, s48, s49
s_add_u32 s57, s48, 10485760
s_branch S_G
slow_4:
s_mov_b32 s37, 100000
tag_6:
v_readfirstlane_b32 s36, v3
s_nop 1
s_cmp_lg_u32 s36, 0
s_cbranch_scc1 tag_7
s_sleep 8
buffer_load_dword v3, off, s[32:35], 0 sc1
s_waitcnt vmcnt(0)
s_sub_u32 s37, s37, 1
s_cbranch_scc0 tag_6
tag_7:
s_mov_b64 exec, 65535
s_mov_b32 s37, 100000
fl_8:
v_cmp_ne_u32 vcc, s36, v2
s_nop 1
s_cmp_eq_u64 vcc, 0
s_cbranch_scc1 fl_9
s_sleep 2
buffer_load_dword v2, v4, s[28:31], s38 offen sc1
s_waitcnt vmcnt(0)
s_sub_u32 s37, s37, 1
s_cbranch_scc0 fl_8
fl_9:
s_mov_b64 exec, -1
s_branch ret_5
.p2align 12
S_C2:
s_setprio 2
s_and_b32 s37, s25, 31
s_lshl_b32 s37, s37, 5
s_lshl_b32 s48, s24, 1
s_add_u32 s37, s37, s48
s_lshl_b32 s37, s37, 7
s_add_u32 s37, s37, 19038208
s_add_u32 s52, s22, s37
s_addc_u32 s53, s23, 0
s_cmp_lt_u32 s24, 2
s_cselect_b32 s51, 1024, 0
s_mov_b32 s37, 100000
sp_32:
s_load_dword s48, s[52:53], 0 glc
s_load_dword s49, s[52:53], 128 glc
s_waitcnt lgkmcnt(0)
s_xor_b32 s48, s48, s36
s_xor_b32 s49, s49, s36
s_or_b32 s48, s48, s49
s_cbranch_scc0 sp_33
s_sleep 1
s_sub_u32 s37, s37, 1
s_cbranch_scc0 sp_32
sp_33:
s_add_u32 m0, s44, 0
s_nop 0
buffer_load_dwordx4 v10, s[28:31], s43 offen sc1 lds
s_add_u32 s43, s43, 164864
s_add_u32 m0, s44, 1024
s_nop 0
buffer_load_dwordx4 v10, s[28:31], s43 offen sc1 lds
s_add_u32 s43, s43, 164864
s_add_u32 m0, s44, 2048
s_nop 0
buffer_load_dwordx4 v10, s[28:31], s43 offen sc1 lds
s_add_u32 s43, s43, 164864
s_add_u32 m0, s44, 3072
s_nop 0
buffer_load_dwordx4 v10, s[28:31], s43 offen sc1 lds
s_add_u32 s43, s43, 164864
s_add_u32 m0, s44, 4096
s_nop 0
buffer_load_dwordx4 v10, s[28:31], s43 offen sc1 lds
s_add_u32 s43, s43, 164864
s_add_u32 m0, s44, 5120
s_nop 0
buffer_load_dwordx4 v10, s[28:31], s43 offen sc1 lds
s_add_u32 s43, s43, 164864
s_add_u32 m0, s44, 6144
s_nop 0
buffer_load_dwordx4 v10, s[28:31], s43 offen sc1 lds
s_add_u32 s43, s43, 164864
s_add_u32 m0, s44, 7168
s_nop 0
buffer_load_dwordx4 v10, s[28:31], s43 offen sc1 lds
s_mul_i32 s43, s42, 16512
s_add_u32 s43, s43, 2621440
s_mov_b32 s44, 0xffff0000
s_waitcnt vmcnt(0)
s_barrier
ds_read2st64_b64 v[108:111], v11 offset0:0 offset1:8
ds_read2st64_b64 v[116:119], v12 offset0:0 offset1:8
ds_read2st64_b64 v[112:115], v11 offset0:4 offset1:12
ds_read2st64_b64 v[120:123], v12 offset0:4 offset1:12
ds_read2st64_b32 v[92:93], v90 offset0:0 offset1:8
ds_read2st64_b32 v[94:95], v90 offset0:16 offset1:24
ds_read2st64_b32 v[100:101], v90 offset0:4 offset1:12
ds_read2st64_b32 v[102:103], v90 offset0:20 offset1:28
ds_read2st64_b32 v[96:97], v91 offset0:0 offset1:8
ds_read2st64_b32 v[98:99], v91 offset0:16 offset1:24
ds_read2st64_b32 v[104:105], v91 offset0:4 offset1:12
ds_read2st64_b32 v[106:107], v91 offset0:20 offset1:28
s_waitcnt lgkmcnt(11)
v_mfma_f32_16x16x32_bf16 v[148:151], v[108:111], v[48:51], 0
v_mfma_f32_16x16x32_bf16 v[164:167], v[108:111], v[52:55], 0
s_waitcnt lgkmcnt(10)
v_mfma_f32_16x16x32_bf16 v[156:159], v[116:119], v[56:59], 0
v_mfma_f32_16x16x32_bf16 v[172:175], v[116:119], v[60:63], 0
s_waitcnt lgkmcnt(9)
v_mfma_f32_16x16x32_bf16 v[152:155], v[112:115], v[48:51], 0
v_mfma_f32_16x16x32_bf16 v[168:171], v[112:115], v[52:55], 0
s_waitcnt lgkmcnt(8)
v_mfma_f32_16x16x32_bf16 v[160:163], v[120:123], v[56:59], 0
v_mfma_f32_16x16x32_bf16 v[176:179], v[120:123], v[60:63], 0
s_waitcnt lgkmcnt(0)
s_setprio 0
v_lshlrev_b32 v124, 16, v92
v_and_b32 v92, s44, v92
v_lshlrev_b32 v125, 16, v93
v_and_b32 v93, s44, v93
v_lshlrev_b32 v126, 16, v94
v_and_b32 v94, s44, v94
v_lshlrev_b32 v127, 16, v95
v_and_b32 v95, s44, v95
v_lshlrev_b32 v128, 16, v96
v_and_b32 v96, s44, v96
v_add_f32 v6, v148, v156
v_add_f32 v7, v164, v172
v_add_f32 v8, v152, v160
v_add_f32 v9, v168, v176
v_mul_f32 v140, v6, v16
v_mul_f32 v142, v7, v16
v_fma_f32 v140, -v7, v32, v140
v_fmac_f32_e64 v142, v6, v32
v_fma_f32 v144, v8, v20, v140
v_fma_f32 v146, v9, v20, v142
v_fma_f32 v144, -v9, v36, v144
v_fma_f32 v146, v8, v36, v146
v_fma_f32 v140, 2.0, v140, -v144
v_fma_f32 v142, 2.0, v142, -v146
v_add_f32 v6, v149, v157
v_add_f32 v7, v165, v173
v_add_f32 v8, v153, v161
v_add_f32 v9, v169, v177
v_mul_f32 v141, v6, v17
v_mul_f32 v143, v7, v17
v_fma_f32 v141, -v7, v33, v141
v_fmac_f32_e64 v143, v6, v33
v_fma_f32 v145, v8, v21, v141
v_fma_f32 v147, v9, v21, v143
v_fma_f32 v145, -v9, v37, v145
v_fma_f32 v147, v8, v37, v147
v_fma_f32 v141, 2.0, v141, -v145
v_fma_f32 v143, 2.0, v143, -v147
v_cvt_pk_bf16_f32 v108, v144, v145
v_cvt_pk_bf16_f32 v109, v146, v147
v_cvt_pk_bf16_f32 v116, v140, v141
v_cvt_pk_bf16_f32 v117, v142, v143
v_add_f32 v6, v150, v158
v_add_f32 v7, v166, v174
v_add_f32 v8, v154, v162
v_add_f32 v9, v170, v178
v_mul_f32 v140, v6, v18
v_mul_f32 v142, v7, v18
v_fma_f32 v140, -v7, v34, v140
v_fmac_f32_e64 v142, v6, v34
v_fma_f32 v144, v8, v22, v140
v_fma_f32 v146, v9, v22, v142
v_fma_f32 v144, -v9, v38, v144
v_fma_f32 v146, v8, v38, v146
v_fma_f32 v140, 2.0, v140, -v144
v_fma_f32 v142, 2.0, v142, -v146
v_add_f32 v6, v151, v159
v_add_f32 v7, v167, v175
v_add_f32 v8, v155, v163
v_add_f32 v9, v171, v179
v_mul_f32 v141, v6, v19
v_mul_f32 v143, v7, v19
v_fma_f32 v141, -v7, v35, v141
v_fmac_f32_e64 v143, v6, v35
v_fma_f32 v145, v8, v23, v141
v_fma_f32 v147, v9, v23, v143
v_fma_f32 v145, -v9, v39, v145
v_fma_f32 v147, v8, v39, v147
v_fma_f32 v141, 2.0, v141, -v145
v_fma_f32 v143, 2.0, v143, -v147
v_cvt_pk_bf16_f32 v110, v144, v145
v_cvt_pk_bf16_f32 v111, v146, v147
v_cvt_pk_bf16_f32 v118, v140, v141
v_cvt_pk_bf16_f32 v119, v142, v143
v_sub_f32 v6, v148, v156
v_sub_f32 v7, v164, v172
v_sub_f32 v8, v152, v160
s_setprio 2
v_sub_f32 v9, v168, v176
v_mfma_f32_16x16x32_bf16 v[180:183], v[64:67], v[108:111], 0
s_setprio 0
v_mul_f32 v140, v6, v24
v_mul_f32 v142, v7, v24
v_fma_f32 v140, -v7, v40, v140
v_fmac_f32_e64 v142, v6, v40
v_fma_f32 v144, v8, v28, v140
v_fma_f32 v146, v9, v28, v142
v_fma_f32 v144, -v9, v44, v144
v_fma_f32 v146, v8, v44, v146
v_fma_f32 v140, 2.0, v140, -v144
v_fma_f32 v142, 2.0, v142, -v146
v_sub_f32 v6, v149, v157
v_sub_f32 v7, v165, v173
v_sub_f32 v8, v153, v161
s_setprio 2
v_sub_f32 v9, v169, v177
v_mfma_f32_16x16x32_bf16 v[196:199], v[68:71], v[108:111], 0
s_setprio 0
v_mul_f32 v141, v6, v25
v_mul_f32 v143, v7, v25
v_fma_f32 v141, -v7, v41, v141
v_fmac_f32_e64 v143, v6, v41
v_fma_f32 v145, v8, v29, v141
v_fma_f32 v147, v9, v29, v143
v_fma_f32 v145, -v9, v45, v145
v_fma_f32 v147, v8, v45, v147
v_fma_f32 v141, 2.0, v141, -v145
v_fma_f32 v143, 2.0, v143, -v147
v_cvt_pk_bf16_f32 v112, v144, v145
v_cvt_pk_bf16_f32 v113, v146, v147
v_cvt_pk_bf16_f32 v120, v140, v141
v_cvt_pk_bf16_f32 v121, v142, v143
v_sub_f32 v6, v150, v158
v_sub_f32 v7, v166, v174
v_sub_f32 v8, v154, v162
s_setprio 2
v_sub_f32 v9, v170, v178
v_mfma_f32_16x16x32_bf16 v[188:191], v[72:75], v[116:119], 0
s_setprio 0
v_mul_f32 v140, v6, v26
v_mul_f32 v142, v7, v26
v_fma_f32 v140, -v7, v42, v140
v_fmac_f32_e64 v142, v6, v42
v_fma_f32 v144, v8, v30, v140
v_fma_f32 v146, v9, v30, v142
v_fma_f32 v144, -v9, v46, v144
v_fma_f32 v146, v8, v46, v146
v_fma_f32 v140, 2.0, v140, -v144
v_fma_f32 v142, 2.0, v142, -v146
v_sub_f32 v6, v151, v159
v_sub_f32 v7, v167, v175
v_sub_f32 v8, v155, v163
s_setprio 2
v_sub_f32 v9, v171, v179
v_mfma_f32_16x16x32_bf16 v[204:207], v[76:79], v[116:119], 0
s_setprio 0
v_mul_f32 v141, v6, v27
v_mul_f32 v143, v7, v27
v_fma_f32 v141, -v7, v43, v141
v_fmac_f32_e64 v143, v6, v43
v_fma_f32 v145, v8, v31, v141
v_fma_f32 v147, v9, v31, v143
v_fma_f32 v145, -v9, v47, v145
v_fma_f32 v147, v8, v47, v147
v_fma_f32 v141, 2.0, v141, -v145
v_fma_f32 v143, 2.0, v143, -v147
v_cvt_pk_bf16_f32 v114, v144, v145
v_cvt_pk_bf16_f32 v115, v146, v147
v_cvt_pk_bf16_f32 v122, v140, v141
s_setprio 2
v_cvt_pk_bf16_f32 v123, v142, v143
v_mfma_f32_16x16x32_bf16 v[184:187], v[64:67], v[112:115], 0
s_setprio 0
v_lshlrev_b32 v129, 16, v97
v_and_b32 v97, s44, v97
v_lshlrev_b32 v130, 16, v98
v_and_b32 v98, s44, v98
v_lshlrev_b32 v131, 16, v99
s_setprio 2
v_and_b32 v99, s44, v99
v_mfma_f32_16x16x32_bf16 v[200:203], v[68:71], v[112:115], 0
s_setprio 0
v_lshlrev_b32 v132, 16, v100
v_and_b32 v100, s44, v100
v_lshlrev_b32 v133, 16, v101
v_and_b32 v101, s44, v101
v_lshlrev_b32 v134, 16, v102
s_setprio 2
v_and_b32 v102, s44, v102
v_mfma_f32_16x16x32_bf16 v[192:195], v[72:75], v[120:123], 0
s_setprio 0
v_lshlrev_b32 v135, 16, v103
v_and_b32 v103, s44, v103
v_lshlrev_b32 v136, 16, v104
v_and_b32 v104, s44, v104
v_lshlrev_b32 v137, 16, v105
s_setprio 2
v_and_b32 v105, s44, v105
v_mfma_f32_16x16x32_bf16 v[208:211], v[76:79], v[120:123], 0
s_setprio 0
v_lshlrev_b32 v138, 16, v106
v_and_b32 v106, s44, v106
v_lshlrev_b32 v139, 16, v107
v_and_b32 v107, s44, v107
v_mul_f32 v6, v180, v124
v_mul_f32 v8, v196, v124
v_fma_f32 v6, -v196, v92, v6
v_fmac_f32 v8, v180, v92
v_mul_f32 v7, v181, v125
v_mul_f32 v9, v197, v125
v_fma_f32 v7, -v197, v93, v7
v_fmac_f32 v9, v181, v93
v_cvt_pk_bf16_f32 v108, v8, v9
v_cvt_pk_bf16_f32 v109, v6, v7
v_mul_f32 v6, v182, v126
v_mul_f32 v8, v198, v126
v_fma_f32 v6, -v198, v94, v6
v_fmac_f32 v8, v182, v94
v_mul_f32 v7, v183, v127
v_mul_f32 v9, v199, v127
v_fma_f32 v7, -v199, v95, v7
v_fmac_f32 v9, v183, v95
v_cvt_pk_bf16_f32 v110, v8, v9
v_cvt_pk_bf16_f32 v111, v6, v7
v_mul_f32 v6, v188, v132
v_mul_f32 v8, v204, v132
v_fma_f32 v6, -v204, v100, v6
s_setprio 2
v_fmac_f32 v8, v188, v100
v_mfma_f32_16x16x32_bf16 v[164:167], v[108:111], v[64:67], 0
s_setprio 0
v_mul_f32 v7, v189, v133
v_mul_f32 v9, v205, v133
v_fma_f32 v7, -v205, v101, v7
v_fmac_f32 v9, v189, v101
v_cvt_pk_bf16_f32 v116, v8, v9
v_cvt_pk_bf16_f32 v117, v6, v7
v_mul_f32 v6, v190, v134
v_mul_f32 v8, v206, v134
v_fma_f32 v6, -v206, v102, v6
s_setprio 2
v_fmac_f32 v8, v190, v102
v_mfma_f32_16x16x32_bf16 v[148:151], v[108:111], v[68:71], 0
s_setprio 0
v_mul_f32 v7, v191, v135
v_mul_f32 v9, v207, v135
v_fma_f32 v7, -v207, v103, v7
v_fmac_f32 v9, v191, v103
v_cvt_pk_bf16_f32 v118, v8, v9
v_cvt_pk_bf16_f32 v119, v6, v7
v_mul_f32 v6, v184, v128
v_mul_f32 v8, v200, v128
v_fma_f32 v6, -v200, v96, v6
s_setprio 2
v_fmac_f32 v8, v184, v96
v_mfma_f32_16x16x32_bf16 v[172:175], v[116:119], v[80:83], 0
s_setprio 0
v_mul_f32 v7, v185, v129
v_mul_f32 v9, v201, v129
v_fma_f32 v7, -v201, v97, v7
v_fmac_f32 v9, v185, v97
v_cvt_pk_bf16_f32 v112, v8, v9
v_cvt_pk_bf16_f32 v113, v6, v7
v_mul_f32 v6, v186, v130
v_mul_f32 v8, v202, v130
v_fma_f32 v6, -v202, v98, v6
s_setprio 2
v_fmac_f32 v8, v186, v98
v_mfma_f32_16x16x32_bf16 v[156:159], v[116:119], v[84:87], 0
s_setprio 0
v_mul_f32 v7, v187, v131
v_mul_f32 v9, v203, v131
v_fma_f32 v7, -v203, v99, v7
v_fmac_f32 v9, v187, v99
v_cvt_pk_bf16_f32 v114, v8, v9
v_cvt_pk_bf16_f32 v115, v6, v7
v_mul_f32 v6, v192, v136
v_mul_f32 v8, v208, v136
v_fma_f32 v6, -v208, v104, v6
s_setprio 2
v_fmac_f32 v8, v192, v104
v_mfma_f32_16x16x32_bf16 v[168:171], v[112:115], v[64:67], 0
s_setprio 0
v_mul_f32 v7, v193, v137
v_mul_f32 v9, v209, v137
v_fma_f32 v7, -v209, v105, v7
v_fmac_f32 v9, v193, v105
v_cvt_pk_bf16_f32 v120, v8, v9
v_cvt_pk_bf16_f32 v121, v6, v7
v_mul_f32 v6, v194, v138
v_mul_f32 v8, v210, v138
v_fma_f32 v6, -v210, v106, v6
s_setprio 2
v_fmac_f32 v8, v194, v106
v_mfma_f32_16x16x32_bf16 v[152:155], v[112:115], v[68:71], 0
s_setprio 0
v_mul_f32 v7, v195, v139
v_mul_f32 v9, v211, v139
v_fma_f32 v7, -v211, v107, v7
v_fmac_f32 v9, v195, v107
v_cvt_pk_bf16_f32 v122, v8, v9
s_setprio 2
v_cvt_pk_bf16_f32 v123, v6, v7
s_nop 1
v_mfma_f32_16x16x32_bf16 v[176:179], v[120:123], v[80:83], 0
v_mfma_f32_16x16x32_bf16 v[160:163], v[120:123], v[84:87], 0
s_setprio 0
v_add_f32 v6, v148, v156
v_add_f32 v7, v164, v172
s_nop 4
v_add_f32 v8, v152, v160
v_add_f32 v9, v168, v176
v_mul_f32 v140, v6, v16
v_mul_f32 v142, v7, v16
v_fmac_f32_e64 v140, v7, v32
v_fma_f32 v142, -v6, v32, v142
v_fma_f32 v144, v8, v20, v140
v_fma_f32 v146, v9, v20, v142
v_fma_f32 v144, v9, v36, v144
v_fma_f32 v146, -v8, v36, v146
v_fma_f32 v140, 2.0, v140, -v144
v_fma_f32 v142, 2.0, v142, -v146
v_add_f32 v6, v149, v157
v_add_f32 v7, v165, v173
v_add_f32 v8, v153, v161
v_add_f32 v9, v169, v177
v_mul_f32 v141, v6, v17
v_mul_f32 v143, v7, v17
v_fmac_f32_e64 v141, v7, v33
v_fma_f32 v143, -v6, v33, v143
v_fma_f32 v145, v8, v21, v141
v_fma_f32 v147, v9, v21, v143
v_fma_f32 v145, v9, v37, v145
v_fma_f32 v147, -v8, v37, v147
v_fma_f32 v141, 2.0, v141, -v145
v_fma_f32 v143, 2.0, v143, -v147
v_cvt_pk_bf16_f32 v108, v146, v147
v_cvt_pk_bf16_f32 v109, v144, v145
v_cvt_pk_bf16_f32 v116, v142, v143
v_cvt_pk_bf16_f32 v117, v140, v141
v_add_f32 v6, v150, v158
v_add_f32 v7, v166, v174
v_add_f32 v8, v154, v162
v_add_f32 v9, v170, v178
v_mul_f32 v140, v6, v18
v_mul_f32 v142, v7, v18
v_fmac_f32_e64 v140, v7, v34
v_fma_f32 v142, -v6, v34, v142
v_fma_f32 v144, v8, v22, v140
v_fma_f32 v146, v9, v22, v142
v_fma_f32 v144, v9, v38, v144
v_fma_f32 v146, -v8, v38, v146
v_fma_f32 v140, 2.0, v140, -v144
v_fma_f32 v142, 2.0, v142, -v146
v_add_f32 v6, v151, v159
v_add_f32 v7, v167, v175
v_add_f32 v8, v155, v163
v_add_f32 v9, v171, v179
v_mul_f32 v141, v6, v19
v_mul_f32 v143, v7, v19
v_fmac_f32_e64 v141, v7, v35
v_fma_f32 v143, -v6, v35, v143
v_fma_f32 v145, v8, v23, v141
v_fma_f32 v147, v9, v23, v143
v_fma_f32 v145, v9, v39, v145
v_fma_f32 v147, -v8, v39, v147
v_fma_f32 v141, 2.0, v141, -v145
v_fma_f32 v143, 2.0, v143, -v147
v_cvt_pk_bf16_f32 v110, v146, v147
v_cvt_pk_bf16_f32 v111, v144, v145
v_cvt_pk_bf16_f32 v118, v142, v143
v_cvt_pk_bf16_f32 v119, v140, v141
v_sub_f32 v6, v148, v156
v_sub_f32 v7, v164, v172
v_sub_f32 v8, v152, v160
s_setprio 2
v_sub_f32 v9, v168, v176
v_mfma_f32_16x16x32_bf16 v[196:199], v[64:67], v[108:111], 0
s_setprio 0
v_mul_f32 v140, v6, v24
v_mul_f32 v142, v7, v24
v_fmac_f32_e64 v140, v7, v40
v_fma_f32 v142, -v6, v40, v142
v_fma_f32 v144, v8, v28, v140
v_fma_f32 v146, v9, v28, v142
v_fma_f32 v144, v9, v44, v144
v_fma_f32 v146, -v8, v44, v146
v_fma_f32 v140, 2.0, v140, -v144
v_fma_f32 v142, 2.0, v142, -v146
v_sub_f32 v6, v149, v157
v_sub_f32 v7, v165, v173
v_sub_f32 v8, v153, v161
s_setprio 2
v_sub_f32 v9, v169, v177
v_mfma_f32_16x16x32_bf16 v[180:183], v[68:71], v[108:111], 0
s_setprio 0
v_mul_f32 v141, v6, v25
v_mul_f32 v143, v7, v25
v_fmac_f32_e64 v141, v7, v41
v_fma_f32 v143, -v6, v41, v143
v_fma_f32 v145, v8, v29, v141
v_fma_f32 v147, v9, v29, v143
v_fma_f32 v145, v9, v45, v145
v_fma_f32 v147, -v8, v45, v147
v_fma_f32 v141, 2.0, v141, -v145
v_fma_f32 v143, 2.0, v143, -v147
v_cvt_pk_bf16_f32 v112, v146, v147
v_cvt_pk_bf16_f32 v113, v144, v145
v_cvt_pk_bf16_f32 v120, v142, v143
v_cvt_pk_bf16_f32 v121, v140, v141
v_sub_f32 v6, v150, v158
v_sub_f32 v7, v166, v174
v_sub_f32 v8, v154, v162
s_setprio 2
v_sub_f32 v9, v170, v178
v_mfma_f32_16x16x32_bf16 v[204:207], v[72:75], v[116:119], 0
s_setprio 0
v_mul_f32 v140, v6, v26
v_mul_f32 v142, v7, v26
v_fmac_f32_e64 v140, v7, v42
v_fma_f32 v142, -v6, v42, v142
v_fma_f32 v144, v8, v30, v140
v_fma_f32 v146, v9, v30, v142
v_fma_f32 v144, v9, v46, v144
v_fma_f32 v146, -v8, v46, v146
v_fma_f32 v140, 2.0, v140, -v144
v_fma_f32 v142, 2.0, v142, -v146
v_sub_f32 v6, v151, v159
v_sub_f32 v7, v167, v175
v_sub_f32 v8, v155, v163
s_setprio 2
v_sub_f32 v9, v171, v179
v_mfma_f32_16x16x32_bf16 v[188:191], v[76:79], v[116:119], 0
s_setprio 0
v_mul_f32 v141, v6, v27
v_mul_f32 v143, v7, v27
v_fmac_f32_e64 v141, v7, v43
v_fma_f32 v143, -v6, v43, v143
v_fma_f32 v145, v8, v31, v141
v_fma_f32 v147, v9, v31, v143
v_fma_f32 v145, v9, v47, v145
v_fma_f32 v147, -v8, v47, v147
v_fma_f32 v141, 2.0, v141, -v145
v_fma_f32 v143, 2.0, v143, -v147
v_cvt_pk_bf16_f32 v114, v146, v147
v_cvt_pk_bf16_f32 v115, v144, v145
v_cvt_pk_bf16_f32 v122, v142, v143
s_setprio 2
s_nop 0
v_cvt_pk_bf16_f32 v123, v140, v141
v_mfma_f32_16x16x32_bf16 v[200:203], v[64:67], v[112:115], 0
v_mfma_f32_16x16x32_bf16 v[184:187], v[68:71], v[112:115], 0
v_mfma_f32_16x16x32_bf16 v[208:211], v[72:75], v[120:123], 0
v_mfma_f32_16x16x32_bf16 v[192:195], v[76:79], v[120:123], 0
v_cvt_pk_bf16_f32 v92, v180, v188
v_cvt_pk_bf16_f32 v93, v181, v189
v_cvt_pk_bf16_f32 v94, v196, v204
v_cvt_pk_bf16_f32 v95, v197, v205
ds_write_b128 v88, v[92:95] offset:32768
v_cvt_pk_bf16_f32 v96, v182, v190
v_cvt_pk_bf16_f32 v97, v183, v191
v_cvt_pk_bf16_f32 v98, v198, v206
v_cvt_pk_bf16_f32 v99, v199, v207
ds_write_b128 v88, v[96:99] offset:34816
v_cvt_pk_bf16_f32 v100, v184, v192
v_cvt_pk_bf16_f32 v101, v185, v193
v_cvt_pk_bf16_f32 v102, v200, v208
v_cvt_pk_bf16_f32 v103, v201, v209
ds_write_b128 v88, v[100:103] offset:33792
v_cvt_pk_bf16_f32 v104, v186, v194
v_cvt_pk_bf16_f32 v105, v187, v195
v_cvt_pk_bf16_f32 v106, v202, v210
v_cvt_pk_bf16_f32 v107, v203, v211
ds_write_b128 v88, v[104:107] offset:35840
s_waitcnt lgkmcnt(0)
s_barrier
ds_read_b128 v[92:95], v13 offset:32768
ds_read_b128 v[96:99], v13 offset:36864
ds_read_b128 v[100:103], v13 offset:40960
ds_read_b128 v[104:107], v13 offset:45056
s_waitcnt lgkmcnt(3)
buffer_store_dwordx4 v[92:95], v14, s[28:31], s43 offen sc1
s_add_u32 s43, s43, 4096
s_waitcnt lgkmcnt(2)
buffer_store_dwordx4 v[96:99], v14, s[28:31], s43 offen sc1
s_add_u32 s43, s43, 4096
s_waitcnt lgkmcnt(1)
buffer_store_dwordx4 v[100:103], v14, s[28:31], s43 offen sc1
s_add_u32 s43, s43, 4096
s_waitcnt lgkmcnt(0)
s_waitcnt vmcnt(2)
buffer_store_dwordx4 v[104:107], v14, s[28:31], s43 offen sc1
s_waitcnt vmcnt(0)
s_barrier
s_cmp_lg_u32 s24, 0
s_cbranch_scc1 arr_34
s_lshr_b32 s37, s42, 4
s_lshl_b32 s37, s37, 7
s_add_u32 s38, s37, 19011584
s_mov_b32 s3, 1
s_atomic_add s3, s[22:23], s38 glc
s_waitcnt lgkmcnt(0)
s_cmp_lg_u32 s3, 15
s_cbranch_scc1 arr_34
s_add_u32 s38, s37, 19040256
v_lshlrev_b32 v2, 5, v4
buffer_store_dword v3, v2, s[28:31], s38 offen sc1
s_mov_b64 exec, -1
arr_34:
s_branch S_R
.p2align 12
T_A2:
s_branch T_G
S_A2:
s_waitcnt vmcnt(7)
s_lshl_b32 s38, s25, 2
s_add_u32 s38, s38, s24
s_cmp_lg_u32 s38, 1
s_cbranch_scc1 ep_20
s_mov_b32 s36, 19005440
v_add_u32 v2, 1, v2
v_or_b32 v2, 0x80000000, v2
s_mov_b64 exec, 1
buffer_store_dword v2, off, s[32:35], 0 sc1
buffer_store_dword v2, off, s[28:31], s36 sc1
s_mov_b64 exec, -1
ep_20:
s_mov_b32 s58, 0xffff0000
v_lshlrev_b32 v96, 16, v10
v_and_b32 v97, s58, v10
v_lshlrev_b32 v98, 16, v11
v_and_b32 v99, s58, v11
v_lshlrev_b32 v100, 16, v12
v_and_b32 v101, s58, v12
v_lshlrev_b32 v102, 16, v13
v_and_b32 v103, s58, v13
v_lshlrev_b32 v104, 16, v14
v_and_b32 v105, s58, v14
v_lshlrev_b32 v106, 16, v16
v_and_b32 v107, s58, v16
v_lshlrev_b32 v108, 16, v17
v_and_b32 v109, s58, v17
v_lshlrev_b32 v110, 16, v18
v_and_b32 v111, s58, v18
v_lshlrev_b32 v112, 16, v19
v_and_b32 v113, s58, v19
v_lshlrev_b32 v114, 16, v20
v_and_b32 v115, s58, v20
v_add_f32 v116, v96, v97
v_add_f32 v118, v106, v107
v_mul_f32 v117, v96, v96
v_mul_f32 v119, v106, v106
v_fmac_f32 v117, v97, v97
v_fmac_f32 v119, v107, v107
v_fmac_f32 v117, v98, v98
v_fmac_f32 v119, v108, v108
v_add_f32 v116, v116, v98
v_add_f32 v118, v118, v108
v_fmac_f32 v117, v99, v99
v_fmac_f32 v119, v109, v109
v_add_f32 v116, v116, v99
v_add_f32 v118, v118, v109
v_fmac_f32 v117, v100, v100
v_fmac_f32 v119, v110, v110
v_add_f32 v116, v116, v100
v_add_f32 v118, v118, v110
v_fmac_f32 v117, v101, v101
v_fmac_f32 v119, v111, v111
v_add_f32 v116, v116, v101
v_add_f32 v118, v118, v111
v_fmac_f32 v117, v102, v102
v_fmac_f32 v119, v112, v112
v_add_f32 v116, v116, v102
v_add_f32 v118, v118, v112
v_fmac_f32 v117, v103, v103
v_fmac_f32 v119, v113, v113
v_add_f32 v116, v116, v103
v_add_f32 v118, v118, v113
v_fmac_f32 v117, v104, v104
v_fmac_f32 v119, v114, v114
v_add_f32 v116, v116, v104
v_add_f32 v118, v118, v114
v_fmac_f32 v117, v105, v105
v_fmac_f32 v119, v115, v115
v_add_f32 v116, v116, v105
v_add_f32_e64 v118, v118, v115
v_add_f32_dpp v117, v117, v117 row_shr:1 row_mask:0xf bank_mask:0xf bound_ctrl:1
v_add_f32_dpp v119, v119, v119 row_shr:1 row_mask:0xf bank_mask:0xf bound_ctrl:1
v_add_f32_dpp v116, v116, v116 row_shr:1 row_mask:0xf bank_mask:0xf bound_ctrl:1
v_add_f32_dpp v118, v118, v118 row_shr:1 row_mask:0xf bank_mask:0xf bound_ctrl:1
v_add_f32_dpp v117, v117, v117 row_shr:2 row_mask:0xf bank_mask:0xf bound_ctrl:1
v_add_f32_dpp v119, v119, v119 row_shr:2 row_mask:0xf bank_mask:0xf bound_ctrl:1
v_add_f32_dpp v116, v116, v116 row_shr:2 row_mask:0xf bank_mask:0xf bound_ctrl:1
v_add_f32_dpp v118, v118, v118 row_shr:2 row_mask:0xf bank_mask:0xf bound_ctrl:1
v_add_f32_dpp v117, v117, v117 row_shr:4 row_mask:0xf bank_mask:0xf bound_ctrl:1
v_add_f32_dpp v119, v119, v119 row_shr:4 row_mask:0xf bank_mask:0xf bound_ctrl:1
v_add_f32_dpp v116, v116, v116 row_shr:4 row_mask:0xf bank_mask:0xf bound_ctrl:1
v_add_f32_dpp v118, v118, v118 row_shr:4 row_mask:0xf bank_mask:0xf bound_ctrl:1
v_add_f32_dpp v117, v117, v117 row_shr:8 row_mask:0xf bank_mask:0xf bound_ctrl:1
v_add_f32_dpp v119, v119, v119 row_shr:8 row_mask:0xf bank_mask:0xf bound_ctrl:1
v_add_f32_dpp v116, v116, v116 row_shr:8 row_mask:0xf bank_mask:0xf bound_ctrl:1
v_add_f32_dpp v118, v118, v118 row_shr:8 row_mask:0xf bank_mask:0xf bound_ctrl:1
v_add_f32_dpp v117, v117, v117 row_bcast:15 row_mask:0xa bank_mask:0xf
v_add_f32_dpp v119, v119, v119 row_bcast:15 row_mask:0xa bank_mask:0xf
v_add_f32_dpp v116, v116, v116 row_bcast:15 row_mask:0xa bank_mask:0xf
v_add_f32_dpp v118, v118, v118 row_bcast:15 row_mask:0xa bank_mask:0xf
v_add_f32_dpp v117, v117, v117 row_bcast:31 row_mask:0xc bank_mask:0xf
v_add_f32_dpp v119, v119, v119 row_bcast:31 row_mask:0xc bank_mask:0xf
v_add_f32_dpp v116, v116, v116 row_bcast:31 row_mask:0xc bank_mask:0xf
v_add_f32_dpp v118, v118, v118 row_bcast:31 row_mask:0xc bank_mask:0xf
s_mov_b32 s56, 0x3acccccd
v_mul_f32 v116, s56, v116
v_mul_f32 v117, s56, v117
v_mul_f32 v118, s56, v118
v_mul_f32 v119, s56, v119
v_fma_f32 v117, -v116, v116, v117
v_fma_f32 v119, -v118, v118, v119
v_max_f32 v117, 0, v117
v_add_f32 v117, 0x3727c5ac, v117
v_max_f32 v119, 0, v119
v_add_f32 v119, 0x3727c5ac, v119
v_rsq_f32 v6, v117
v_rsq_f32 v7, v119
v_readlane_b32 s58, v116, 63
v_readlane_b32 s59, v118, 63
v_readlane_b32 s56, v6, 63
v_readlane_b32 s57, v7, 63
v_mov_b32 v28, s58
v_mov_b32 v29, s59
v_mul_f32 v28, s56, v28
v_mul_f32 v29, s57, v29
v_fma_f32 v96, v96, s56, -v28
v_fma_f32 v106, v106, s57, -v29
v_fma_f32 v97, v97, s56, -v28
v_fma_f32 v107, v107, s57, -v29
v_fma_f32 v98, v98, s56, -v28
v_fma_f32 v108, v108, s57, -v29
v_fma_f32 v99, v99, s56, -v28
v_fma_f32 v109, v109, s57, -v29
v_fma_f32 v100, v100, s56, -v28
v_fma_f32 v110, v110, s57, -v29
v_fma_f32 v101, v101, s56, -v28
v_fma_f32 v111, v111, s57, -v29
v_fma_f32 v102, v102, s56, -v28
v_fma_f32 v112, v112, s57, -v29
v_fma_f32 v103, v103, s56, -v28
v_fma_f32 v113, v113, s57, -v29
v_fma_f32 v104, v104, s56, -v28
v_fma_f32 v114, v114, s57, -v29
v_fma_f32 v105, v105, s56, -v28
v_fma_f32 v115, v115, s57, -v29
v_add_f32 v6, v96, v106
v_add_f32 v7, v97, v107
v_sub_f32 v8, v96, v106
v_sub_f32 v9, v97, v107
v_cvt_pk_bf16_f32 v10, v6, v7
v_cvt_pk_bf16_f32 v16, v8, v9
v_add_f32 v6, v98, v108
v_add_f32 v7, v99, v109
v_sub_f32 v8, v98, v108
v_sub_f32 v9, v99, v109
v_cvt_pk_bf16_f32 v11, v6, v7
v_cvt_pk_bf16_f32 v17, v8, v9
v_add_f32 v6, v100, v110
v_add_f32 v7, v101, v111
v_sub_f32 v8, v100, v110
v_sub_f32 v9, v101, v111
v_cvt_pk_bf16_f32 v12, v6, v7
v_cvt_pk_bf16_f32 v18, v8, v9
v_add_f32 v6, v102, v112
v_add_f32 v7, v103, v113
v_sub_f32 v8, v102, v112
v_sub_f32 v9, v103, v113
v_cvt_pk_bf16_f32 v13, v6, v7
v_cvt_pk_bf16_f32 v19, v8, v9
v_add_f32 v6, v104, v114
v_add_f32 v7, v105, v115
v_sub_f32 v8, v104, v114
v_sub_f32 v9, v105, v115
v_cvt_pk_bf16_f32 v14, v6, v7
v_cvt_pk_bf16_f32 v20, v8, v9
ds_write_b128 v84, v[10:13] offset:12288
ds_write_b128 v84, v[16:19] offset:17408
ds_write_b32 v85, v14 offset:13312
ds_write_b32 v85, v20 offset:18432
s_lshl_b32 s56, s24, 3
v_mov_b32 v6, s56
s_mov_b32 exec_lo, 0x0
s_mov_b32 exec_hi, 0x80000000
ds_write_b64 v6, v[116:117] offset:22528
ds_write_b64 v6, v[118:119] offset:22560
s_mov_b64 exec, -1
s_waitcnt vmcnt(4) lgkmcnt(0)
s_barrier
ds_read_b64_tr_b16 v[120:121], v86 offset:12288
ds_read_b64_tr_b16 v[122:123], v87 offset:12288
ds_read_b64_tr_b16 v[124:125], v86 offset:12320
ds_read_b64_tr_b16 v[126:127], v87 offset:12320
ds_read_b64_tr_b16 v[128:129], v86 offset:14848
ds_read_b64_tr_b16 v[130:131], v87 offset:14848
ds_read_b64_tr_b16 v[132:133], v86 offset:14880
ds_read_b64_tr_b16 v[134:135], v87 offset:14880
s_waitcnt lgkmcnt(6)
v_mfma_f32_16x16x32_bf16 v[136:139], v[120:123], v[30:33], 0
v_mfma_f32_16x16x32_bf16 v[152:155], v[120:123], v[34:37], 0
s_waitcnt lgkmcnt(4)
v_mfma_f32_16x16x32_bf16 v[140:143], v[124:127], v[30:33], 0
v_mfma_f32_16x16x32_bf16 v[156:159], v[124:127], v[34:37], 0
s_waitcnt lgkmcnt(2)
v_mfma_f32_16x16x32_bf16 v[144:147], v[128:131], v[30:33], 0
v_mfma_f32_16x16x32_bf16 v[160:163], v[128:131], v[34:37], 0
s_waitcnt lgkmcnt(0)
v_mfma_f32_16x16x32_bf16 v[148:151], v[132:135], v[30:33], 0
v_mfma_f32_16x16x32_bf16 v[164:167], v[132:135], v[34:37], 0
ds_read_u16 v10, v90 offset:0
ds_read_u16 v168, v90 offset:6144
ds_read_u16 v11, v90 offset:1284
ds_read_u16 v169, v90 offset:7428
ds_read_u16 v12, v90 offset:2568
ds_read_u16 v170, v90 offset:8712
ds_read_u16 v13, v90 offset:3852
ds_read_u16 v171, v90 offset:9996
v_mul_f32 v6, v136, v62
v_mul_f32 v8, v152, v62
v_fma_f32 v6, -v152, v70, v6
v_fmac_f32 v8, v136, v70
v_mul_f32 v7, v137, v63
v_mul_f32 v9, v153, v63
v_fma_f32 v7, -v153, v71, v7
v_fmac_f32 v9, v137, v71
v_cvt_pk_bf16_f32 v96, v6, v7
v_cvt_pk_bf16_f32 v106, v8, v9
v_mul_f32 v6, v138, v64
v_mul_f32 v8, v154, v64
v_fma_f32 v6, -v154, v72, v6
v_fmac_f32 v8, v138, v72
v_mul_f32 v7, v139, v65
v_mul_f32 v9, v155, v65
v_fma_f32 v7, -v155, v73, v7
v_fmac_f32 v9, v139, v73
v_cvt_pk_bf16_f32 v97, v6, v7
v_cvt_pk_bf16_f32 v107, v8, v9
v_mul_f32 v6, v140, v66
v_mul_f32 v8, v156, v66
v_fma_f32 v6, -v156, v74, v6
v_fmac_f32 v8, v140, v74
v_mul_f32 v7, v141, v67
v_mul_f32 v9, v157, v67
v_fma_f32 v7, -v157, v75, v7
v_fmac_f32 v9, v141, v75
v_cvt_pk_bf16_f32 v98, v6, v7
v_cvt_pk_bf16_f32 v108, v8, v9
s_waitcnt lgkmcnt(0)
ds_read_u16 v14, v91 offset:0
ds_read_u16 v172, v91 offset:6144
ds_read_u16 v15, v91 offset:1284
ds_read_u16 v173, v91 offset:7428
ds_read_u16 v16, v91 offset:2568
ds_read_u16 v174, v91 offset:8712
ds_read_u16 v17, v91 offset:3852
ds_read_u16 v175, v91 offset:9996
v_mul_f32 v6, v142, v68
v_mul_f32 v8, v158, v68
v_fma_f32 v6, -v158, v76, v6
v_fmac_f32 v8, v142, v76
v_mul_f32 v7, v143, v69
v_mul_f32 v9, v159, v69
v_fma_f32 v7, -v159, v77, v7
v_fmac_f32 v9, v143, v77
v_cvt_pk_bf16_f32 v99, v6, v7
v_cvt_pk_bf16_f32 v109, v8, v9
v_mul_f32 v6, v144, v62
v_mul_f32 v8, v160, v62
v_fma_f32 v6, -v160, v70, v6
v_fmac_f32 v8, v144, v70
v_mfma_f32_16x16x32_bf16 v[120:123], v[38:41], v[96:99], 0
v_mul_f32 v7, v145, v63
v_mul_f32 v9, v161, v63
v_fma_f32 v7, -v161, v71, v7
v_fmac_f32_e64 v9, v145, v71
v_mfma_f32_16x16x32_bf16 v[180:183], v[38:41], v[106:109], 0
v_cvt_pk_bf16_f32 v100, v6, v7
v_cvt_pk_bf16_f32 v110, v8, v9
v_mul_f32 v6, v146, v64
v_mul_f32 v8, v162, v64
v_fma_f32 v6, -v162, v72, v6
v_fmac_f32 v8, v146, v72
v_mfma_f32_16x16x32_bf16 v[120:123], v[42:45], v[106:109], v[120:123]
v_mul_f32 v7, v147, v65
v_mul_f32 v9, v163, v65
v_fma_f32 v7, -v163, v73, v7
v_fmac_f32 v9, v147, v73
v_mfma_f32_16x16x32_bf16 v[180:183], v[46:49], v[96:99], v[180:183]
v_cvt_pk_bf16_f32 v101, v6, v7
v_cvt_pk_bf16_f32 v111, v8, v9
s_waitcnt lgkmcnt(0)
ds_read_u16 v18, v92 offset:0
ds_read_u16 v176, v92 offset:6144
ds_read_u16 v19, v92 offset:1284
ds_read_u16 v177, v92 offset:7428
ds_read_u16 v20, v92 offset:2568
ds_read_u16 v178, v92 offset:8712
ds_read_u16 v21, v92 offset:3852
ds_read_u16 v179, v92 offset:9996
v_mul_f32 v6, v148, v66
v_mul_f32 v8, v164, v66
v_fma_f32 v6, -v164, v74, v6
v_fmac_f32 v8, v148, v74
v_mfma_f32_16x16x32_bf16 v[124:127], v[50:53], v[96:99], 0
v_mul_f32 v7, v149, v67
v_mul_f32 v9, v165, v67
v_fma_f32 v7, -v165, v75, v7
v_fmac_f32_e64 v9, v149, v75
v_mfma_f32_16x16x32_bf16 v[184:187], v[58:61], v[106:109], 0
v_cvt_pk_bf16_f32 v102, v6, v7
v_cvt_pk_bf16_f32 v112, v8, v9
v_mul_f32 v6, v150, v68
v_mul_f32 v8, v166, v68
v_fma_f32 v6, -v166, v76, v6
v_fmac_f32 v8, v150, v76
v_mfma_f32_16x16x32_bf16 v[124:127], v[54:57], v[106:109], v[124:127]
v_mul_f32 v7, v151, v69
v_mul_f32 v9, v167, v69
v_fma_f32 v7, -v167, v77, v7
v_fmac_f32 v9, v151, v77
v_mfma_f32_16x16x32_bf16 v[184:187], v[54:57], v[96:99], v[184:187]
v_cvt_pk_bf16_f32 v103, v6, v7
v_cvt_pk_bf16_f32 v113, v8, v9
s_nop 0
s_nop 0
v_mfma_f32_16x16x32_bf16 v[128:131], v[38:41], v[100:103], 0
v_mfma_f32_16x16x32_bf16 v[188:191], v[38:41], v[110:113], 0
v_lshl_or_b32 v168, v168, 16, v10
v_lshl_or_b32 v169, v169, 16, v11
v_lshl_or_b32 v170, v170, 16, v12
v_lshl_or_b32 v171, v171, 16, v13
ds_write_b128 v93, v[168:171] offset:33024
v_mfma_f32_16x16x32_bf16 v[128:131], v[42:45], v[110:113], v[128:131]
v_mfma_f32_16x16x32_bf16 v[188:191], v[46:49], v[100:103], v[188:191]
v_mfma_f32_16x16x32_bf16 v[132:135], v[50:53], v[100:103], 0
v_lshl_or_b32 v172, v172, 16, v14
v_lshl_or_b32 v173, v173, 16, v15
v_lshl_or_b32 v174, v174, 16, v16
v_lshl_or_b32 v175, v175, 16, v17
ds_write_b128 v93, v[172:175] offset:37120
v_mfma_f32_16x16x32_bf16 v[192:195], v[58:61], v[110:113], 0
v_mfma_f32_16x16x32_bf16 v[132:135], v[54:57], v[110:113], v[132:135]
v_mfma_f32_16x16x32_bf16 v[192:195], v[54:57], v[100:103], v[192:195]
s_waitcnt lgkmcnt(2)
s_nop 0
v_lshl_or_b32 v176, v176, 16, v18
v_lshl_or_b32 v177, v177, 16, v19
v_lshl_or_b32 v178, v178, 16, v20
v_lshl_or_b32 v179, v179, 16, v21
ds_write_b128 v93, v[176:179] offset:41216
s_mov_b32 exec_lo, 0x7ff07fe
s_mov_b32 exec_hi, 0x7ff07ff
v_cvt_pk_bf16_f32 v8, v120, v128
v_cvt_pk_bf16_f32 v9, v180, v188
ds_write_b64 v88, v[8:9] offset:0
s_mov_b32 exec_lo, 0x7ff07ff
v_cvt_pk_bf16_f32 v6, v121, v129
v_cvt_pk_bf16_f32 v7, v181, v189
ds_write_b64 v88, v[6:7] offset:320
v_cvt_pk_bf16_f32 v8, v122, v130
v_cvt_pk_bf16_f32 v9, v182, v190
ds_write_b64 v88, v[8:9] offset:640
v_cvt_pk_bf16_f32 v6, v123, v131
v_cvt_pk_bf16_f32 v7, v183, v191
ds_write_b64 v88, v[6:7] offset:960
s_mov_b64 exec, -1
s_waitcnt vmcnt(0)
v_mfma_f32_16x16x32_bf16 v[236:239], v[232:235], v[216:219], 0
v_mfma_f32_16x16x32_bf16 v[236:239], v[232:235], v[220:223], v[236:239]
v_mfma_f32_16x16x32_bf16 v[236:239], v[232:235], v[224:227], v[236:239]
v_mfma_f32_16x16x32_bf16 v[236:239], v[232:235], v[228:231], v[236:239]
s_mov_b64 exec, 1
v_mul_f32 v124, 0.5, v124
v_mul_f32 v184, 0.5, v184
v_mul_f32 v132, 0.5, v132
v_mul_f32_e64 v192, 0.5, v192
s_mov_b32 exec_lo, 0x3fe03ff
s_mov_b32 exec_hi, 0x3fe03fe
v_cvt_pk_bf16_f32 v8, v124, v132
v_cvt_pk_bf16_f32 v9, v184, v192
ds_write_b64 v89, v[8:9] offset:960
s_mov_b32 exec_lo, 0x3fe03fe
v_cvt_pk_bf16_f32 v6, v125, v133
v_cvt_pk_bf16_f32 v7, v185, v193
ds_write_b64 v89, v[6:7] offset:640
v_cvt_pk_bf16_f32 v8, v126, v134
v_cvt_pk_bf16_f32 v9, v186, v194
ds_write_b64 v89, v[8:9] offset:320
v_cvt_pk_bf16_f32 v6, v127, v135
v_cvt_pk_bf16_f32 v7, v187, v195
ds_write_b64 v89, v[6:7] offset:0
s_mov_b32 exec_lo, -1
s_mov_b32 exec_hi, 0
ds_write_b128 v240, v[236:239] offset:45312
s_mov_b64 exec, -1
s_mov_b32 s56, s69
s_waitcnt lgkmcnt(0)
s_barrier
ds_read_b128 v[62:65], v94 offset:22784
ds_read_b128 v[66:69], v94 offset:24832
ds_read_b128 v[70:73], v94 offset:26880
ds_read_b128 v[74:77], v94 offset:28928
ds_read_b128 v[78:81], v94 offset:30976
s_waitcnt lgkmcnt(4)
buffer_store_dwordx4 v[62:65], v93, s[28:31], s56 offen sc1
s_add_u32 s56, s56, 4096
s_waitcnt lgkmcnt(3)
buffer_store_dwordx4 v[66:69], v93, s[28:31], s56 offen sc1
s_add_u32 s56, s56, 4096
s_waitcnt lgkmcnt(2)
buffer_store_dwordx4 v[70:73], v93, s[28:31], s56 offen sc1
s_add_u32 s56, s56, 4096
s_waitcnt lgkmcnt(1)
s_waitcnt vmcnt(2)
buffer_store_dwordx4 v[74:77], v93, s[28:31], s56 offen sc1
s_add_u32 s56, s56, 4096
s_waitcnt lgkmcnt(0)
s_waitcnt vmcnt(2)
buffer_store_dwordx4 v[78:81], v93, s[28:31], s56 offen sc1
s_cmp_lg_u32 s24, 3
s_cbranch_scc1 stat_21
ds_read_b128 v[6:9], v22 offset:22528
s_lshl_b32 s61, s27, 8
s_add_u32 s61, s61, 18874368
s_mov_b64 exec, 0xfff0
s_waitcnt lgkmcnt(0)
v_mov_b32 v6, 0
s_mov_b64 exec, 0xffff
buffer_store_dwordx4 v[6:9], v22, s[28:31], s61 offen sc1
s_mov_b64 exec, -1
stat_21:
s_cmp_lg_u32 s24, 2
s_cbranch_scc1 cs_22
v_lshrrev_b32 v6, 1, v1
v_and_b32 v7, 1, v1
v_lshl_add_u32 v6, v7, 5, v6
v_lshlrev_b32 v6, 2, v6
ds_read2st64_b32 v[216:217], v6 offset0:177 offset1:178
ds_read2st64_b32 v[218:219], v6 offset0:179 offset1:180
ds_read2st64_b32 v[220:221], v6 offset0:181 offset1:182
ds_read2st64_b32 v[222:223], v6 offset0:183 offset1:184
s_waitcnt lgkmcnt(0)
v_add_f32 v216, v216, v217
v_add_f32 v216, v216, v218
v_add_f32 v216, v216, v219
v_add_f32 v216, v216, v220
v_add_f32 v216, v216, v221
v_add_f32 v216, v216, v222
v_add_f32 v216, v216, v223
buffer_store_dword v216, v23, s[28:31], s68 offen sc1
cs_22:
buffer_load_dword v3, off, s[32:35], 0 sc1
s_add_u32 s25, s25, 160
s_and_b32 s25, s25, 255
s_cmp_ge_u32 s25, 160
s_cbranch_scc1 L_prep
s_waitcnt vmcnt(0)
s_barrier
s_mov_b32 s37, 100000
tag_30:
v_readfirstlane_b32 s36, v3
s_nop 1
s_cmp_lg_u32 s36, 0
s_cbranch_scc1 tag_31
s_sleep 8
buffer_load_dword v3, off, s[32:35], 0 sc1
s_waitcnt vmcnt(0)
s_sub_u32 s37, s37, 1
s_cbranch_scc0 tag_30
tag_31:
s_cmp_lg_u32 s24, 0
s_cbranch_scc1 arr_29
s_lshl_b32 s37, s26, 7
s_add_u32 s38, s37, 19009536
s_mov_b32 s3, 1
s_atomic_add s3, s[22:23], s38 glc
s_waitcnt lgkmcnt(0)
s_cmp_lg_u32 s3, 31
s_cbranch_scc1 arr_29
s_add_u32 s38, s37, 19038208
v_lshlrev_b32 v2, 5, v4
s_mov_b32 exec_hi, 0xff
buffer_store_dword v3, v2, s[28:31], s38 offen sc1
s_mov_b64 exec, -1
arr_29:
s_lshl_b32 s41, s24, 1
s_lshl_b32 s40, 3, s41
s_mov_b32 s41, 0
s_setprio 0
s_branch S_C
.p2align 12
T_G:
s_branch L_touched
S_G:
s_nop 0
v_pk_mul_f32 v[232:233], v[116:117], v[116:117]
v_pk_mul_f32 v[234:235], v[118:119], v[118:119]
v_pk_mul_f32 v[236:237], v[120:121], v[120:121]
v_pk_mul_f32 v[238:239], v[122:123], v[122:123]
buffer_load_dwordx4 v[64:67], v11, s[28:31], s67 offen offset:2048 sc1
v_pk_fma_f32 v[232:233], v[232:233], v[110:111], v[110:111] op_sel:[0,1,0] op_sel_hi:[1,1,0]
v_pk_fma_f32 v[234:235], v[234:235], v[110:111], v[110:111] op_sel:[0,1,0] op_sel_hi:[1,1,0]
v_pk_fma_f32 v[236:237], v[236:237], v[110:111], v[110:111] op_sel:[0,1,0] op_sel_hi:[1,1,0]
v_pk_fma_f32 v[238:239], v[238:239], v[110:111], v[110:111] op_sel:[0,1,0] op_sel_hi:[1,1,0]
v_pk_mul_f32 v[232:233], v[232:233], v[116:117]
v_pk_mul_f32 v[234:235], v[234:235], v[118:119]
v_pk_mul_f32 v[236:237], v[236:237], v[120:121]
v_pk_mul_f32 v[238:239], v[238:239], v[122:123]
buffer_load_dwordx4 v[68:71], v11, s[28:31], s67 offen offset:3072 sc1
v_exp_f32 v232, v232
v_exp_f32 v233, v233
v_exp_f32 v234, v234
v_exp_f32 v235, v235
v_exp_f32 v236, v236
v_exp_f32 v237, v237
v_exp_f32 v238, v238
v_exp_f32 v239, v239
buffer_load_dwordx4 v[72:75], v12, s[28:31], s67 offen offset:0 sc1
v_pk_mul_f32 v[116:117], v[116:117], v[124:125]
v_pk_mul_f32 v[118:119], v[118:119], v[126:127]
v_pk_mul_f32 v[120:121], v[120:121], v[128:129]
v_pk_mul_f32 v[122:123], v[122:123], v[130:131]
v_pk_fma_f32 v[232:233], v[232:233], v[104:105], v[104:105] op_sel:[0,1,1] op_sel_hi:[1,1,1]
v_pk_fma_f32 v[234:235], v[234:235], v[104:105], v[104:105] op_sel:[0,1,1] op_sel_hi:[1,1,1]
v_pk_fma_f32 v[236:237], v[236:237], v[104:105], v[104:105] op_sel:[0,1,1] op_sel_hi:[1,1,1]
v_pk_fma_f32 v[238:239], v[238:239], v[104:105], v[104:105] op_sel:[0,1,1] op_sel_hi:[1,1,1]
v_rcp_f32 v232, v232
v_rcp_f32 v233, v233
v_rcp_f32 v234, v234
v_rcp_f32 v235, v235
v_rcp_f32 v236, v236
v_rcp_f32 v237, v237
v_rcp_f32 v238, v238
v_rcp_f32 v239, v239
v_pk_mul_f32 v[116:117], v[116:117], v[232:233]
v_pk_mul_f32 v[118:119], v[118:119], v[234:235]
v_pk_mul_f32 v[120:121], v[120:121], v[236:237]
v_pk_mul_f32 v[122:123], v[122:123], v[238:239]
v_cvt_pk_bf16_f32 v124, v116, v117
v_cvt_pk_bf16_f32 v125, v118, v119
v_cvt_pk_bf16_f32 v126, v120, v121
v_cvt_pk_bf16_f32 v127, v122, v123
buffer_store_dwordx4 v[124:127], v97, s[28:31], s53 offen offset:0 sc1
s_add_u32 s53, s53, 4096
v_pk_mul_f32 v[232:233], v[132:133], v[132:133]
v_pk_mul_f32 v[234:235], v[134:135], v[134:135]
v_pk_mul_f32 v[236:237], v[136:137], v[136:137]
v_pk_mul_f32 v[238:239], v[138:139], v[138:139]
buffer_load_dwordx4 v[76:79], v11, s[28:31], s68 offen offset:0 sc1
v_pk_fma_f32 v[232:233], v[232:233], v[112:113], v[112:113] op_sel:[0,1,0] op_sel_hi:[1,1,0]
v_pk_fma_f32 v[234:235], v[234:235], v[112:113], v[112:113] op_sel:[0,1,0] op_sel_hi:[1,1,0]
v_pk_fma_f32 v[236:237], v[236:237], v[112:113], v[112:113] op_sel:[0,1,0] op_sel_hi:[1,1,0]
v_pk_fma_f32 v[238:239], v[238:239], v[112:113], v[112:113] op_sel:[0,1,0] op_sel_hi:[1,1,0]
v_pk_mul_f32 v[232:233], v[232:233], v[132:133]
v_pk_mul_f32 v[234:235], v[234:235], v[134:135]
v_pk_mul_f32 v[236:237], v[236:237], v[136:137]
v_pk_mul_f32 v[238:239], v[238:239], v[138:139]
buffer_load_dwordx4 v[80:83], v11, s[28:31], s68 offen offset:1024 sc1
v_exp_f32 v232, v232
v_exp_f32 v233, v233
v_exp_f32 v234, v234
v_exp_f32 v235, v235
v_exp_f32 v236, v236
v_exp_f32 v237, v237
v_exp_f32 v238, v238
v_exp_f32 v239, v239
buffer_load_dwordx4 v[84:87], v11, s[28:31], s68 offen offset:2048 sc1
v_pk_mul_f32 v[132:133], v[132:133], v[140:141]
v_pk_mul_f32 v[134:135], v[134:135], v[142:143]
v_pk_mul_f32 v[136:137], v[136:137], v[144:145]
v_pk_mul_f32 v[138:139], v[138:139], v[146:147]
v_pk_fma_f32 v[232:233], v[232:233], v[106:107], v[106:107] op_sel:[0,1,1] op_sel_hi:[1,1,1]
v_pk_fma_f32 v[234:235], v[234:235], v[106:107], v[106:107] op_sel:[0,1,1] op_sel_hi:[1,1,1]
v_pk_fma_f32 v[236:237], v[236:237], v[106:107], v[106:107] op_sel:[0,1,1] op_sel_hi:[1,1,1]
v_pk_fma_f32 v[238:239], v[238:239], v[106:107], v[106:107] op_sel:[0,1,1] op_sel_hi:[1,1,1]
v_rcp_f32 v232, v232
v_rcp_f32 v233, v233
v_rcp_f32 v234, v234
v_rcp_f32 v235, v235
v_rcp_f32 v236, v236
v_rcp_f32 v237, v237
v_rcp_f32 v238, v238
v_rcp_f32 v239, v239
v_pk_mul_f32 v[132:133], v[132:133], v[232:233]
v_pk_mul_f32 v[134:135], v[134:135], v[234:235]
v_pk_mul_f32 v[136:137], v[136:137], v[236:237]
v_pk_mul_f32 v[138:139], v[138:139], v[238:239]
v_cvt_pk_bf16_f32 v140, v132, v133
v_cvt_pk_bf16_f32 v141, v134, v135
v_cvt_pk_bf16_f32 v142, v136, v137
v_cvt_pk_bf16_f32 v143, v138, v139
buffer_store_dwordx4 v[140:143], v97, s[28:31], s56 offen offset:0 sc1
s_add_u32 s56, s56, 4096
v_pk_mul_f32 v[232:233], v[148:149], v[148:149]
v_pk_mul_f32 v[234:235], v[150:151], v[150:151]
v_pk_mul_f32 v[236:237], v[152:153], v[152:153]
v_pk_mul_f32 v[238:239], v[154:155], v[154:155]
buffer_load_dwordx4 v[88:91], v11, s[28:31], s68 offen offset:3072 sc1
v_pk_fma_f32 v[232:233], v[232:233], v[114:115], v[114:115] op_sel:[0,1,0] op_sel_hi:[1,1,0]
v_pk_fma_f32 v[234:235], v[234:235], v[114:115], v[114:115] op_sel:[0,1,0] op_sel_hi:[1,1,0]
v_pk_fma_f32 v[236:237], v[236:237], v[114:115], v[114:115] op_sel:[0,1,0] op_sel_hi:[1,1,0]
v_pk_fma_f32 v[238:239], v[238:239], v[114:115], v[114:115] op_sel:[0,1,0] op_sel_hi:[1,1,0]
v_pk_mul_f32 v[232:233], v[232:233], v[148:149]
v_pk_mul_f32 v[234:235], v[234:235], v[150:151]
v_pk_mul_f32 v[236:237], v[236:237], v[152:153]
v_pk_mul_f32 v[238:239], v[238:239], v[154:155]
buffer_load_dwordx4 v[92:95], v12, s[28:31], s68 offen offset:0 sc1
v_exp_f32 v232, v232
v_exp_f32 v233, v233
v_exp_f32 v234, v234
v_exp_f32 v235, v235
v_exp_f32 v236, v236
v_exp_f32 v237, v237
v_exp_f32 v238, v238
v_exp_f32 v239, v239
s_add_u32 m0, s60, 0
s_nop 0
buffer_load_dwordx4 v11, s[28:31], s70 offen sc1 lds
v_pk_mul_f32 v[148:149], v[148:149], v[156:157]
v_pk_mul_f32 v[150:151], v[150:151], v[158:159]
v_pk_mul_f32 v[152:153], v[152:153], v[160:161]
v_pk_mul_f32 v[154:155], v[154:155], v[162:163]
v_pk_fma_f32 v[232:233], v[232:233], v[108:109], v[108:109] op_sel:[0,1,1] op_sel_hi:[1,1,1]
v_pk_fma_f32 v[234:235], v[234:235], v[108:109], v[108:109] op_sel:[0,1,1] op_sel_hi:[1,1,1]
v_pk_fma_f32 v[236:237], v[236:237], v[108:109], v[108:109] op_sel:[0,1,1] op_sel_hi:[1,1,1]
v_pk_fma_f32 v[238:239], v[238:239], v[108:109], v[108:109] op_sel:[0,1,1] op_sel_hi:[1,1,1]
v_rcp_f32 v232, v232
v_rcp_f32 v233, v233
v_rcp_f32 v234, v234
v_rcp_f32 v235, v235
v_rcp_f32 v236, v236
v_rcp_f32 v237, v237
v_rcp_f32 v238, v238
v_rcp_f32 v239, v239
v_pk_mul_f32 v[148:149], v[148:149], v[232:233]
v_pk_mul_f32 v[150:151], v[150:151], v[234:235]
v_pk_mul_f32 v[152:153], v[152:153], v[236:237]
v_pk_mul_f32 v[154:155], v[154:155], v[238:239]
v_cvt_pk_bf16_f32 v156, v148, v149
v_cvt_pk_bf16_f32 v157, v150, v151
v_cvt_pk_bf16_f32 v158, v152, v153
v_cvt_pk_bf16_f32 v159, v154, v155
buffer_store_dwordx4 v[156:159], v97, s[28:31], s57 offen offset:0 sc1
s_add_u32 s57, s57, 4096
v_pk_mul_f32 v[232:233], v[164:165], v[164:165]
v_pk_mul_f32 v[234:235], v[166:167], v[166:167]
v_pk_mul_f32 v[236:237], v[168:169], v[168:169]
v_pk_mul_f32 v[238:239], v[170:171], v[170:171]
s_add_u32 m0, s60, 0
s_nop 0
buffer_load_dwordx4 v11, s[28:31], s70 offen offset:1024 sc1 lds
v_pk_fma_f32 v[232:233], v[232:233], v[110:111], v[110:111] op_sel:[0,1,0] op_sel_hi:[1,1,0]
v_pk_fma_f32 v[234:235], v[234:235], v[110:111], v[110:111] op_sel:[0,1,0] op_sel_hi:[1,1,0]
v_pk_fma_f32 v[236:237], v[236:237], v[110:111], v[110:111] op_sel:[0,1,0] op_sel_hi:[1,1,0]
v_pk_fma_f32 v[238:239], v[238:239], v[110:111], v[110:111] op_sel:[0,1,0] op_sel_hi:[1,1,0]
v_pk_mul_f32 v[232:233], v[232:233], v[164:165]
v_pk_mul_f32 v[234:235], v[234:235], v[166:167]
v_pk_mul_f32 v[236:237], v[236:237], v[168:169]
v_pk_mul_f32 v[238:239], v[238:239], v[170:171]
s_add_u32 m0, s60, 0
s_nop 0
buffer_load_dwordx4 v11, s[28:31], s70 offen offset:2048 sc1 lds
v_exp_f32 v232, v232
v_exp_f32 v233, v233
v_exp_f32 v234, v234
v_exp_f32 v235, v235
v_exp_f32 v236, v236
v_exp_f32 v237, v237
v_exp_f32 v238, v238
v_exp_f32 v239, v239
s_add_u32 m0, s60, 0
s_nop 0
buffer_load_dwordx4 v11, s[28:31], s70 offen offset:3072 sc1 lds
v_pk_mul_f32 v[164:165], v[164:165], v[172:173]
v_pk_mul_f32 v[166:167], v[166:167], v[174:175]
v_pk_mul_f32 v[168:169], v[168:169], v[176:177]
v_pk_mul_f32 v[170:171], v[170:171], v[178:179]
v_pk_fma_f32 v[232:233], v[232:233], v[104:105], v[104:105] op_sel:[0,1,1] op_sel_hi:[1,1,1]
v_pk_fma_f32 v[234:235], v[234:235], v[104:105], v[104:105] op_sel:[0,1,1] op_sel_hi:[1,1,1]
v_pk_fma_f32 v[236:237], v[236:237], v[104:105], v[104:105] op_sel:[0,1,1] op_sel_hi:[1,1,1]
v_pk_fma_f32 v[238:239], v[238:239], v[104:105], v[104:105] op_sel:[0,1,1] op_sel_hi:[1,1,1]
v_rcp_f32 v232, v232
v_rcp_f32 v233, v233
v_rcp_f32 v234, v234
v_rcp_f32 v235, v235
v_rcp_f32 v236, v236
v_rcp_f32 v237, v237
v_rcp_f32 v238, v238
v_rcp_f32 v239, v239
v_pk_mul_f32 v[164:165], v[164:165], v[232:233]
v_pk_mul_f32 v[166:167], v[166:167], v[234:235]
v_pk_mul_f32 v[168:169], v[168:169], v[236:237]
v_pk_mul_f32 v[170:171], v[170:171], v[238:239]
v_cvt_pk_bf16_f32 v172, v164, v165
v_cvt_pk_bf16_f32 v173, v166, v167
v_cvt_pk_bf16_f32 v174, v168, v169
v_cvt_pk_bf16_f32 v175, v170, v171
buffer_store_dwordx4 v[172:175], v97, s[28:31], s53 offen offset:0 sc1
v_pk_mul_f32 v[232:233], v[180:181], v[180:181]
v_pk_mul_f32 v[234:235], v[182:183], v[182:183]
v_pk_mul_f32 v[236:237], v[184:185], v[184:185]
v_pk_mul_f32 v[238:239], v[186:187], v[186:187]
s_add_u32 m0, s60, 4096
s_nop 0
s_nop 0
buffer_load_dwordx4 v12, s[28:31], s70 offen sc1 lds
v_pk_fma_f32 v[232:233], v[232:233], v[112:113], v[112:113] op_sel:[0,1,0] op_sel_hi:[1,1,0]
v_pk_fma_f32 v[234:235], v[234:235], v[112:113], v[112:113] op_sel:[0,1,0] op_sel_hi:[1,1,0]
v_pk_fma_f32 v[236:237], v[236:237], v[112:113], v[112:113] op_sel:[0,1,0] op_sel_hi:[1,1,0]
v_pk_fma_f32 v[238:239], v[238:239], v[112:113], v[112:113] op_sel:[0,1,0] op_sel_hi:[1,1,0]
v_pk_mul_f32 v[232:233], v[232:233], v[180:181]
v_pk_mul_f32 v[234:235], v[234:235], v[182:183]
v_pk_mul_f32 v[236:237], v[236:237], v[184:185]
v_pk_mul_f32 v[238:239], v[238:239], v[186:187]
s_add_u32 m0, s60, 5120
s_nop 0
buffer_load_dwordx4 v11, s[28:31], s71 offen sc1 lds
v_exp_f32 v232, v232
v_exp_f32 v233, v233
v_exp_f32 v234, v234
v_exp_f32 v235, v235
v_exp_f32 v236, v236
v_exp_f32 v237, v237
v_exp_f32 v238, v238
v_exp_f32 v239, v239
s_add_u32 m0, s60, 5120
s_nop 0
buffer_load_dwordx4 v11, s[28:31], s71 offen offset:1024 sc1 lds
v_pk_mul_f32 v[180:181], v[180:181], v[188:189]
v_pk_mul_f32 v[182:183], v[182:183], v[190:191]
v_pk_mul_f32 v[184:185], v[184:185], v[192:193]
v_pk_mul_f32 v[186:187], v[186:187], v[194:195]
v_pk_fma_f32 v[232:233], v[232:233], v[106:107], v[106:107] op_sel:[0,1,1] op_sel_hi:[1,1,1]
v_pk_fma_f32 v[234:235], v[234:235], v[106:107], v[106:107] op_sel:[0,1,1] op_sel_hi:[1,1,1]
v_pk_fma_f32 v[236:237], v[236:237], v[106:107], v[106:107] op_sel:[0,1,1] op_sel_hi:[1,1,1]
v_pk_fma_f32 v[238:239], v[238:239], v[106:107], v[106:107] op_sel:[0,1,1] op_sel_hi:[1,1,1]
v_rcp_f32 v232, v232
v_rcp_f32 v233, v233
v_rcp_f32 v234, v234
v_rcp_f32 v235, v235
v_rcp_f32 v236, v236
v_rcp_f32 v237, v237
v_rcp_f32 v238, v238
v_rcp_f32 v239, v239
v_pk_mul_f32 v[180:181], v[180:181], v[232:233]
v_pk_mul_f32 v[182:183], v[182:183], v[234:235]
v_pk_mul_f32 v[184:185], v[184:185], v[236:237]
v_pk_mul_f32 v[186:187], v[186:187], v[238:239]
v_cvt_pk_bf16_f32 v188, v180, v181
v_cvt_pk_bf16_f32 v189, v182, v183
v_cvt_pk_bf16_f32 v190, v184, v185
v_cvt_pk_bf16_f32 v191, v186, v187
buffer_store_dwordx4 v[188:191], v97, s[28:31], s56 offen offset:0 sc1
v_pk_mul_f32 v[232:233], v[196:197], v[196:197]
v_pk_mul_f32 v[234:235], v[198:199], v[198:199]
v_pk_mul_f32 v[236:237], v[200:201], v[200:201]
v_pk_mul_f32 v[238:239], v[202:203], v[202:203]
v_pk_fma_f32 v[232:233], v[232:233], v[114:115], v[114:115] op_sel:[0,1,0] op_sel_hi:[1,1,0]
v_pk_fma_f32 v[234:235], v[234:235], v[114:115], v[114:115] op_sel:[0,1,0] op_sel_hi:[1,1,0]
v_pk_fma_f32 v[236:237], v[236:237], v[114:115], v[114:115] op_sel:[0,1,0] op_sel_hi:[1,1,0]
v_pk_fma_f32 v[238:239], v[238:239], v[114:115], v[114:115] op_sel:[0,1,0] op_sel_hi:[1,1,0]
v_pk_mul_f32 v[232:233], v[232:233], v[196:197]
v_pk_mul_f32 v[234:235], v[234:235], v[198:199]
v_pk_mul_f32 v[236:237], v[236:237], v[200:201]
v_pk_mul_f32 v[238:239], v[238:239], v[202:203]
v_exp_f32 v232, v232
v_exp_f32 v233, v233
v_exp_f32 v234, v234
v_exp_f32 v235, v235
v_exp_f32 v236, v236
v_exp_f32 v237, v237
v_exp_f32 v238, v238
v_exp_f32 v239, v239
v_pk_mul_f32 v[196:197], v[196:197], v[204:205]
v_pk_mul_f32 v[198:199], v[198:199], v[206:207]
v_pk_mul_f32 v[200:201], v[200:201], v[208:209]
v_pk_mul_f32 v[202:203], v[202:203], v[210:211]
v_pk_fma_f32 v[232:233], v[232:233], v[108:109], v[108:109] op_sel:[0,1,1] op_sel_hi:[1,1,1]
v_pk_fma_f32 v[234:235], v[234:235], v[108:109], v[108:109] op_sel:[0,1,1] op_sel_hi:[1,1,1]
v_pk_fma_f32 v[236:237], v[236:237], v[108:109], v[108:109] op_sel:[0,1,1] op_sel_hi:[1,1,1]
v_pk_fma_f32 v[238:239], v[238:239], v[108:109], v[108:109] op_sel:[0,1,1] op_sel_hi:[1,1,1]
v_rcp_f32 v232, v232
v_rcp_f32 v233, v233
v_rcp_f32 v234, v234
v_rcp_f32 v235, v235
v_rcp_f32 v236, v236
v_rcp_f32 v237, v237
v_rcp_f32 v238, v238
v_rcp_f32 v239, v239
v_pk_mul_f32 v[196:197], v[196:197], v[232:233]
v_pk_mul_f32 v[198:199], v[198:199], v[234:235]
v_pk_mul_f32 v[200:201], v[200:201], v[236:237]
v_pk_mul_f32 v[202:203], v[202:203], v[238:239]
v_cvt_pk_bf16_f32 v204, v196, v197
v_cvt_pk_bf16_f32 v205, v198, v199
v_cvt_pk_bf16_f32 v206, v200, v201
v_cvt_pk_bf16_f32 v207, v202, v203
buffer_store_dwordx4 v[204:207], v97, s[28:31], s57 offen offset:0 sc1
s_lshl_b32 s52, s62, 8
s_add_u32 s58, s52, 256
s_sub_u32 s52, 512, s52
s_mov_b32 s27, 8
L_join:
s_lshr_b32 s59, s50, 1
s_lshl_b32 s59, s59, 2
s_bfe_u32 s48, s25, 0x20001
s_add_u32 s59, s59, s48
s_cmp_eq_u32 s27, 8
s_cselect_b32 s48, 3, 2
s_cselect_b32 s52, 2, 3
s_cselect_b32 s58, 7, 3
s_mul_i32 s48, s48, s62
s_sub_u32 s48, s50, s48
s_lshl_b32 s48, s48, 2
s_and_b32 s49, s25, 6
s_add_u32 s48, s48, s49
s_lshl_b32 s59, s48, 8
s_add_u32 s59, s59, 18874496
v_mov_b32 v2, s52
v_lshlrev_b32 v4, 11, v1
s_waitcnt vmcnt(9)
s_barrier
s_cmp_lg_u32 s24, 1
s_cbranch_scc1 ag_10
s_cmp_lg_u32 s27, 8
s_cbranch_scc1 ag_10
s_mov_b32 exec_lo, s58
s_mov_b32 exec_hi, 0
buffer_atomic_add v2, v4, s[28:31], s59 offen offset:0 sc1
s_mov_b64 exec, -1
ag_10:
s_mov_b64 s[44:45], s[18:19]
s_mov_b32 s46, 2621440
s_mov_b32 s47, 0x00020000
v_lshl_add_u32 v244, v1, 4, s60
v_lshrrev_b32 v6, 5, v1
v_lshlrev_b32 v6, 5, v6
v_xor_b32 v245, v6, v244
v_xor_b32 v246, 64, v245
v_xor_b32 v247, 128, v245
v_xor_b32 v248, 192, v245
s_lshl_b32 s49, s61, 3
v_and_b32 v6, 7, v1
v_lshrrev_b32 v7, 3, v1
v_lshlrev_b32 v8, 1, v6
v_xor_b32 v8, v8, v7
v_xor_b32_e64 v8, s49, v8
s_mul_i32 s48, s62, 5120
v_lshl_add_u32 v8, v6, 5, v8
v_lshl_add_u32 v249, v8, 4, s48
v_and_b32 v8, 3, v7
v_lshrrev_b32 v9, 2, v7
v_lshl_add_u32 v8, v9, 5, v8
v_mul_u32_u24 v8, 2560, v8
v_add_lshl_u32 v251, v8, v6, 4
v_lshl_add_u32 v8, v7, 6, v6
v_lshlrev_b32 v253, 4, v8
v_and_b32 v6, 3, v1
v_bfe_u32 v7, v1, 2, 3
v_and_b32 v8, 2, v1
v_xor_b32 v8, v8, v7
v_xor_b32 v8, s49, v8
s_add_u32 s48, s48, 4096
v_lshl_add_u32 v8, v6, 4, v8
v_and_b32 v9, 32, v1
v_mad_u32_u24 v8, v9, 20, v8
v_lshl_add_u32 v250, v8, 4, s48
v_mad_u32_u24 v254, v9, 3, v1
v_lshlrev_b32 v254, 3, v254
v_lshrrev_b32 v9, 3, v9
v_and_b32 v8, 3, v7
v_lshrrev_b32 v7, 2, v7
v_lshl_add_u32 v8, v7, 5, v8
v_lshl_add_u32 v8, v8, 5, v9
v_mul_u32_u24 v8, 160, v8
v_add_lshl_u32 v252, v8, v6, 3
s_lshr_b32 s48, s63, 2
s_lshl_b32 s48, s48, 4
s_and_b32 s49, s63, 3
s_add_u32 s48, s48, s49
s_lshl_b32 s48, s48, 3
s_add_u32 s48, s48, s24
s_mul_i32 s48, s48, 1280
s_lshl_b32 s49, s64, 7
s_add_u32 s53, s48, s49
s_add_u32 s51, s53, 5120
s_lshl_b32 s56, s64, 5
s_add_u32 s56, s56, s48
s_lshl_b32 s55, s63, 2
s_add_u32 s55, s55, s24
s_lshl_b32 s48, s63, 3
s_add_u32 s48, s48, s24
s_lshl_b32 s57, s48, 13
s_add_u32 s57, s57, s49
s_add_u32 s57, s57, 7864320
s_lshl_b32 s54, s48, 8
s_lshl_b32 s49, s64, 16
s_add_u32 s54, s54, s49
s_add_u32 s54, s54, 9961472
buffer_load_dwordx4 v[96:99], v11, s[28:31], s69 offen offset:0 sc1
buffer_load_dwordx4 v[100:103], v11, s[28:31], s69 offen offset:1024 sc1
buffer_load_dwordx4 v[104:107], v11, s[28:31], s69 offen offset:2048 sc1
buffer_load_dwordx4 v[108:111], v11, s[28:31], s69 offen offset:3072 sc1
buffer_load_dwordx4 v[112:115], v12, s[28:31], s69 offen offset:0 sc1
s_add_u32 m0, s60, 5120
s_nop 0
buffer_load_dwordx4 v11, s[28:31], s71 offen offset:2048 sc1 lds
s_add_u32 m0, s60, 5120
s_nop 0
buffer_load_dwordx4 v11, s[28:31], s71 offen offset:3072 sc1 lds
s_add_u32 m0, s60, 9216
s_nop 0
buffer_load_dwordx4 v12, s[28:31], s71 offen sc1 lds
s_branch S_Q
.p2align 6
T_C:
s_branch T_Q
S_C:
s_mov_b32 s42, s25
v_and_b32 v6, 15, v1
v_cvt_f32_u32 v10, v6
v_lshrrev_b32 v7, 4, v1
v_cvt_f32_u32 v11, v7
v_mul_f32 v11, 4.0, v11
s_lshl_b32 s43, s42, 2
s_add_u32 s43, s43, s24
s_sub_u32 s43, s43, 320
s_cselect_b32 s3, 0, 0.5
s_mul_i32 s44, s43, 3277
s_lshr_b32 s44, s44, 16
s_mul_i32 s44, s44, 20
s_sub_u32 s44, s43, s44
s_cmp_eq_u32 s43, 319
s_cselect_b32 s44, 10, s44
s_sub_u32 s44, s44, 10
s_cmp_lt_u32 s44, 9
s_cselect_b32 s44, 0x80000000, 0
s_xor_b32 s44, s44, s3
s_mov_b32 s43, 0x80008000
v_add_f32 v13, s44, v10
v_mul_f32 v13, 0x3d800000, v13
v_mul_f32 v12, v11, v13
v_cos_f32 v6, v12
v_sin_f32 v8, v12
v_add_f32 v12, v12, v13
v_cos_f32 v7, v12
v_sin_f32 v9, v12
v_add_f32 v12, v12, v13
v_cvt_pk_bf16_f32 v48, v6, v7
v_cvt_pk_bf16_f32 v49, v8, v9
v_cos_f32 v6, v12
v_sin_f32 v8, v12
v_add_f32 v12, v12, v13
v_cos_f32 v7, v12
v_sin_f32 v9, v12
v_cvt_pk_bf16_f32 v50, v6, v7
v_cvt_pk_bf16_f32 v51, v8, v9
v_xor_b32 v52, s43, v49
v_mov_b32 v53, v48
v_xor_b32 v54, s43, v51
v_mov_b32 v55, v50
v_add_f32 v13, s44, v10
v_mul_f32 v13, 0x3d800000, v13
v_add_f32 v12, 0.5, v11
v_mul_f32 v12, v12, v13
v_cos_f32 v6, v12
v_sin_f32 v8, v12
v_add_f32 v12, v12, v13
v_cos_f32 v7, v12
v_sin_f32 v9, v12
v_add_f32 v12, v12, v13
v_cvt_pk_bf16_f32 v56, v6, v7
v_cvt_pk_bf16_f32 v57, v8, v9
v_cos_f32 v6, v12
v_sin_f32 v8, v12
v_add_f32 v12, v12, v13
v_cos_f32 v7, v12
v_sin_f32 v9, v12
v_cvt_pk_bf16_f32 v58, v6, v7
v_cvt_pk_bf16_f32 v59, v8, v9
v_xor_b32 v60, s43, v57
v_mov_b32 v61, v56
v_xor_b32 v62, s43, v59
v_mov_b32 v63, v58
v_mul_f32 v13, 0x3d800000, v10
v_mul_f32 v12, v11, v13
v_cos_f32 v6, v12
v_sin_f32 v8, v12
v_add_f32 v12, v12, v13
v_cos_f32 v7, v12
v_sin_f32 v9, v12
v_add_f32 v12, v12, v13
v_cvt_pk_bf16_f32 v64, v6, v7
v_cvt_pk_bf16_f32 v65, v8, v9
v_cos_f32 v6, v12
v_sin_f32 v8, v12
v_add_f32 v12, v12, v13
v_cos_f32 v7, v12
v_sin_f32 v9, v12
v_cvt_pk_bf16_f32 v66, v6, v7
v_cvt_pk_bf16_f32 v67, v8, v9
v_xor_b32 v68, s43, v65
v_mov_b32 v69, v64
v_xor_b32 v70, s43, v67
v_mov_b32 v71, v66
v_add_f32 v13, 0.5, v10
v_mul_f32 v13, 0x3d800000, v13
v_mul_f32 v12, v11, v13
v_cos_f32 v6, v12
v_sin_f32 v8, v12
v_add_f32 v12, v12, v13
v_cos_f32 v7, v12
v_sin_f32 v9, v12
v_add_f32 v12, v12, v13
v_cvt_pk_bf16_f32 v72, v6, v7
v_cvt_pk_bf16_f32 v73, v8, v9
v_cos_f32 v6, v12
v_sin_f32 v8, v12
v_add_f32 v12, v12, v13
v_cos_f32 v7, v12
v_sin_f32 v9, v12
v_cvt_pk_bf16_f32 v74, v6, v7
v_cvt_pk_bf16_f32 v75, v8, v9
v_xor_b32 v76, s43, v73
v_mov_b32 v77, v72
v_xor_b32 v78, s43, v75
v_mov_b32 v79, v74
v_mul_f32 v13, 0x3d800000, v10
v_add_f32 v12, 0.5, v11
v_mul_f32 v12, v12, v13
v_cos_f32 v6, v12
v_sin_f32 v8, v12
v_add_f32 v12, v12, v13
v_cos_f32 v7, v12
v_sin_f32 v9, v12
v_add_f32 v12, v12, v13
v_cvt_pk_bf16_f32 v80, v6, v7
v_cvt_pk_bf16_f32 v81, v8, v9
v_cos_f32 v6, v12
v_sin_f32 v8, v12
v_add_f32 v12, v12, v13
v_cos_f32 v7, v12
v_sin_f32 v9, v12
v_cvt_pk_bf16_f32 v82, v6, v7
v_cvt_pk_bf16_f32 v83, v8, v9
v_xor_b32 v84, s43, v81
v_mov_b32 v85, v80
v_xor_b32 v86, s43, v83
v_mov_b32 v87, v82
v_mul_f32 v13, 0xba800000, v10
v_mul_f32 v12, v11, v13
v_mul_f32 v14, 0x41500000, v13
v_cos_f32 v16, v12
v_sin_f32 v32, v12
v_add_f32 v12, v12, v13
v_cos_f32 v17, v12
v_sin_f32 v33, v12
v_add_f32 v12, v12, v13
v_cos_f32 v18, v12
v_sin_f32 v34, v12
v_add_f32 v12, v12, v13
v_cos_f32 v19, v12
v_sin_f32 v35, v12
v_add_f32 v12, v12, v14
v_cos_f32 v20, v12
v_sin_f32 v36, v12
v_add_f32 v12, v12, v13
v_cos_f32 v21, v12
v_sin_f32 v37, v12
v_add_f32 v12, v12, v13
v_cos_f32 v22, v12
v_sin_f32 v38, v12
v_add_f32 v12, v12, v13
v_cos_f32 v23, v12
v_sin_f32 v39, v12
v_add_f32 v13, 0xbc800000, v13
v_mul_f32 v12, v11, v13
v_mul_f32 v14, 0x41500000, v13
v_cos_f32 v24, v12
v_sin_f32 v40, v12
v_add_f32 v12, v12, v13
v_cos_f32 v25, v12
v_sin_f32 v41, v12
v_add_f32 v12, v12, v13
v_cos_f32 v26, v12
v_sin_f32 v42, v12
v_add_f32 v12, v12, v13
v_cos_f32 v27, v12
v_sin_f32 v43, v12
v_add_f32 v12, v12, v14
v_cos_f32 v28, v12
v_sin_f32 v44, v12
v_add_f32 v12, v12, v13
v_cos_f32 v29, v12
v_sin_f32 v45, v12
v_add_f32 v12, v12, v13
v_cos_f32 v30, v12
v_sin_f32 v46, v12
v_add_f32 v12, v12, v13
v_cos_f32 v31, v12
v_sin_f32 v47, v12
v_lshrrev_b32 v6, 3, v1
v_xor_b32 v7, v6, v1
v_and_b32 v8, 7, v7
v_mul_u32_u24 v6, 1288, v6
v_add_lshl_u32 v10, v6, v8, 4
v_and_b32 v7, 3, v7
v_and_b32 v6, -4, v0
v_add_lshl_u32 v13, v6, v7, 4
v_lshlrev_b32 v14, 4, v0
v_and_b32 v9, 48, v1
v_mad_u32_u24 v8, v9, 3, v1
v_xor_b32 v6, s24, v1
v_and_b32 v6, 7, v6
v_lshl_add_u32 v6, v8, 3, v6
v_lshlrev_b32 v11, 4, v6
v_add_u32 v12, 8, v11
v_lshrrev_b32 v6, 1, v1
v_xor_b32 v6, s24, v6
v_and_b32 v6, 3, v6
v_lshl_add_u32 v6, v8, 2, v6
v_lshlrev_b32 v88, 4, v6
s_add_u32 s43, s24, 4
v_bfe_u32 v6, v1, 2, 2
v_xor_b32 v7, s43, v6
v_lshl_add_u32 v6, v6, 3, v7
v_lshl_add_u32 v6, v9, 5, v6
v_and_b32 v7, 3, v1
v_lshl_add_u32 v6, v6, 2, v7
v_lshlrev_b32 v90, 2, v6
v_xor_b32 v91, 576, v90
s_mul_i32 s43, s24, 1318912
s_lshl_b32 s44, s42, 7
s_add_u32 s43, s43, s44
s_add_u32 s43, s43, 20971520
s_lshl_b32 s44, s24, 13
s_branch S_C2
.p2align 12
T_R:
s_branch L_touched
S_R:
r2_23:
s_lshl_b32 s40, 0x111, s24
s_and_b32 s40, s40, 0x3ff
s_mov_b32 s41, 0
s_setprio 0
s_and_b32 s46, s24, 1
s_lshr_b32 s47, s24, 1
v_lshrrev_b32 v10, 4, v1
v_and_b32 v11, 15, v1
v_cvt_f32_u32 v12, v10
v_cvt_f32_u32 v13, v11
s_lshl_b32 s42, s46, 4
v_add_u32 v6, s42, v11
v_cvt_f32_u32 v14, v6
v_lshrrev_b32 v6, 2, v1
v_mul_u32_u24 v8, 1032, v6
v_and_b32 v7, 3, v1
v_add_lshl_u32 v15, v8, v7, 4
s_lshl_b32 s48, s27, 6
s_mul_i32 s49, s24, 264192
s_add_u32 s48, s48, s49
s_add_u32 s48, s48, 2621440
s_lshl_b32 s49, s24, 10
v_mov_b32 v32, 0
v_mov_b32 v19, 0
v_mov_b32 v33, 0
v_mov_b32 v23, 0
v_mov_b32 v34, 0
v_mov_b32 v27, 0
v_mov_b32 v35, 0
v_mov_b32_e64 v31, 0
ds_write_b128 v32, v[32:35] offset:10496
v_mul_f32 v81, 0x3d000000, v14
v_mul_f32 v80, 0x41000000, v12
v_mul_f32 v80, v80, v81
v_cos_f32 v6, v80
v_sin_f32 v8, v80
v_add_f32 v80, v80, v81
v_cos_f32 v7, v80
v_sin_f32 v9, v80
v_add_f32 v80, v80, v81
v_cvt_pk_bf16_f32 v64, v6, v7
v_cvt_pk_bf16_f32 v68, v8, v9
v_cos_f32 v6, v80
v_sin_f32 v8, v80
v_add_f32 v80, v80, v81
v_cos_f32 v7, v80
v_sin_f32 v9, v80
v_add_f32 v80, v80, v81
v_cvt_pk_bf16_f32 v65, v6, v7
v_cvt_pk_bf16_f32 v69, v8, v9
v_cos_f32 v6, v80
v_sin_f32 v8, v80
v_add_f32 v80, v80, v81
v_cos_f32 v7, v80
v_sin_f32 v9, v80
v_add_f32 v80, v80, v81
v_cvt_pk_bf16_f32 v66, v6, v7
v_cvt_pk_bf16_f32 v70, v8, v9
v_cos_f32 v6, v80
v_sin_f32 v8, v80
v_add_f32 v80, v80, v81
v_cos_f32 v7, v80
v_sin_f32 v9, v80
v_cvt_pk_bf16_f32 v67, v6, v7
v_cvt_pk_bf16_f32 v71, v8, v9
v_lshrrev_b32_e64 v6, 5, v1
v_mul_u32_u24 v6, 0x8000, v6
v_lshl_or_b32 v6, v6, 16, v6
v_xor_b32 v7, 0x80008000, v6
v_xor_b32 v76, v64, v6
v_xor_b32 v72, v68, v7
v_xor_b32 v77, v65, v6
v_xor_b32 v73, v69, v7
v_xor_b32 v78, v66, v6
v_xor_b32 v74, v70, v7
v_xor_b32 v79, v67, v6
v_xor_b32 v75, v71, v7
s_mov_b32 s42, 0x35cccccd
v_mul_f32 v81, 0xbd4ccccd, v13
v_mul_f32 v80, v12, v81
v_cos_f32 v6, v80
v_sin_f32 v7, v80
v_fmac_f32 v80, 4.0, v81
v_mul_f32 v6, s42, v6
v_mul_f32 v7, s42, v7
v_cvt_pk_bf16_f32 v82, v6, v7
v_cos_f32 v6, v80
v_sin_f32 v7, v80
v_fmac_f32 v80, 4.0, v81
v_mul_f32 v6, s42, v6
v_mul_f32 v7, s42, v7
v_cvt_pk_bf16_f32 v83, v6, v7
v_cos_f32 v6, v80
v_sin_f32 v7, v80
v_mul_f32 v6, s42, v6
v_mul_f32 v7, s42, v7
v_cvt_pk_bf16_f32 v84, v6, v7
v_mov_b32 v85, 0
v_add_f32 v81, 0xbf4ccccd, v81
v_mul_f32 v80, v12, v81
v_cos_f32 v6, v80
v_sin_f32 v7, v80
v_fmac_f32 v80, 4.0, v81
v_mul_f32 v6, s42, v6
v_mul_f32 v7, s42, v7
v_cvt_pk_bf16_f32 v86, v6, v7
v_cos_f32 v6, v80
v_sin_f32 v7, v80
v_fmac_f32 v80, 4.0, v81
v_mul_f32 v6, s42, v6
v_mul_f32 v7, s42, v7
v_cvt_pk_bf16_f32 v87, v6, v7
v_cos_f32 v6, v80
v_sin_f32 v7, v80
v_mul_f32 v6, s42, v6
v_mul_f32 v7, s42, v7
v_cvt_pk_bf16_f32 v88, v6, v7
v_mov_b32 v89, 0
s_setprio 2
s_and_b32 s37, s25, 63
s_lshl_b32 s37, s37, 5
s_lshl_b32 s52, s24, 0
s_add_u32 s37, s37, s52
s_lshl_b32 s37, s37, 7
s_add_u32 s37, s37, 19040256
s_add_u32 s56, s22, s37
s_addc_u32 s57, s23, 0
s_cmp_lt_u32 s24, 2
s_cselect_b32 s55, 1024, 0
s_mov_b32 s37, 100000
sp_35:
s_load_dword s52, s[56:57], 0 glc
s_load_dword s53, s[56:57], 512 glc
s_load_dword s54, s[56:57], s55 glc
s_waitcnt lgkmcnt(0)
s_xor_b32 s52, s52, s36
s_xor_b32 s53, s53, s36
s_xor_b32 s54, s54, s36
s_or_b32 s52, s52, s54
s_or_b32 s52, s52, s53
s_cbranch_scc0 sp_36
s_sleep 1
s_sub_u32 s37, s37, 1
s_cbranch_scc0 sp_35
sp_36:
s_add_u32 m0, s49, 256
s_nop 0
buffer_load_dwordx4 v15, s[28:31], s48 offen sc1 lds
s_add_u32 s48, s48, 1056768
s_add_u32 m0, s49, 4352
s_nop 0
buffer_load_dwordx4 v15, s[28:31], s48 offen sc1 lds
s_add_u32 s48, s48, 1056768
s_cmp_ge_u32 s24, 2
s_cbranch_scc1 r2skip_37
s_add_u32 m0, s49, 8448
s_nop 0
buffer_load_dwordx4 v15, s[28:31], s48 offen sc1 lds
r2skip_37:
s_setprio 0
s_lshr_b32 s42, s27, 5
s_mul_i32 s42, s42, 96
s_add_u32 s42, s42, s27
s_mul_i32 s42, s42, s47
s_mul_i32 s43, s47, 0x3c800000
v_cvt_f32_u32_e64 v6, s42
v_mul_f32 v6, 0x3a000000, v6
v_mul_f32 v81, 0x3acccccd, v14
v_fma_f32 v80, v12, v81, v6
v_cos_f32 v90, v80
v_sin_f32 v102, v80
v_add_f32 v6, s43, v80
v_cos_f32 v91, v6
v_sin_f32 v103, v6
v_add_f32 v6, s43, v6
v_cos_f32 v92, v6
v_sin_f32 v104, v6
v_add_f32 v6, s43, v6
v_cos_f32 v93, v6
v_sin_f32 v105, v6
v_fmac_f32 v80, 4.0, v81
v_cos_f32 v94, v80
v_sin_f32 v106, v80
v_add_f32 v6, s43, v80
v_cos_f32 v95, v6
v_sin_f32 v107, v6
v_add_f32 v6, s43, v6
v_cos_f32 v96, v6
v_sin_f32 v108, v6
v_add_f32 v6, s43, v6
v_cos_f32 v97, v6
v_sin_f32 v109, v6
v_fmac_f32 v80, 4.0, v81
v_cos_f32 v98, v80
v_sin_f32 v110, v80
v_add_f32 v6, s43, v80
v_cos_f32 v99, v6
v_sin_f32 v111, v6
v_add_f32 v6, s43, v6
v_cos_f32 v100, v6
v_sin_f32 v112, v6
v_add_f32 v6, s43, v6
v_cos_f32 v101, v6
v_sin_f32 v113, v6
v_bfe_u32 v6, v1, 2, 2
v_lshl_add_u32 v6, v10, 3, v6
v_mul_u32_u24 v6, 20, v6
v_and_b32 v7, 3, v1
v_add_lshl_u32 v6, v6, v7, 4
s_mul_i32 s42, s47, 5120
s_add_u32 s43, s42, 10480
s_add_u32 s42, s42, 240
v_add_u32 v8, s42, v6
v_mov_b32 v9, 64
s_mov_b32 exec_lo, 0
v_sub_u32 v8, s43, v6
v_mov_b32 v9, 0xffffffc0
s_mov_b32 exec_lo, -1
v_mad_i32_i24 v114, v9, 0, v8
v_mad_i32_i24 v115, v9, 20, v8
v_mad_i32_i24 v116, v9, 1, v8
v_mad_i32_i24 v117, v9, 21, v8
v_mad_i32_i24 v118, v9, 2, v8
v_mad_i32_i24 v119, v9, 22, v8
s_mov_b32 exec_lo, 0x1
s_mov_b32 exec_hi, 0x11111110
v_mov_b32 v114, 10496
s_mov_b32 exec_lo, 0x0
s_mov_b32 exec_hi, 0x11111111
v_mov_b32 v115, 10496
s_mov_b32 exec_lo, 0x88888888
s_mov_b32 exec_hi, 0xcccccccc
v_mov_b32 v118, 10496
s_mov_b32 exec_lo, 0x88888888
s_mov_b32 exec_hi, 0xcccccccc
v_mov_b32 v119, 10496
s_mov_b64 exec, -1
s_mul_i32 s42, s47, 11520
s_lshl_b32 s43, s46, 6
s_add_u32 s42, s42, s43
v_mul_u32_u24 v12, 144, v11
v_lshl_add_u32 v12, v10, 4, v12
v_add_u32 v12, s42, v12
v_lshrrev_b32_e64 v6, 2, v1
s_mul_i32 s43, s24, 2880
v_mul_u32_u24 v6, 144, v6
v_lshl_add_u32 v6, v7, 5, v6
v_add_u32_e64 v13, s43, v6
v_bfe_u32 v6, v1, 1, 2
v_mul_u32_u24 v6, 2880, v6
v_mul_u32_u24 v8, 144, v10
v_bfe_u32 v9, v1, 3, 1
v_lshlrev_b32 v9, 6, v9
v_add3_u32 v6, v6, v8, v9
v_and_b32 v8, 1, v1
v_lshl_add_u32 v14, v8, 5, v6
v_lshlrev_b32 v80, 4, v1
v_lshrrev_b32 v6, 3, v1
v_lshlrev_b32 v6, 12, v6
v_and_b32 v8, 7, v1
v_add_lshl_u32 v81, v6, v8, 4
s_lshl_b32 s44, s27, 13
s_add_u32 s44, s44, s49
s_add_u32 s44, s44, 7864320
s_add_u32 s45, s44, 4096
s_lshl_b32 s42, s27, 8
s_add_u32 s42, s42, 9961472
s_setprio 2
s_waitcnt vmcnt(0) lgkmcnt(0)
s_barrier
ds_read_b64_tr_b16 v[32:33], v114
ds_read_b64_tr_b16 v[34:35], v115
ds_read_b64_tr_b16 v[44:45], v114 offset:8
ds_read_b64_tr_b16 v[46:47], v115 offset:8
ds_read_b64_tr_b16 v[36:37], v116
ds_read_b64_tr_b16 v[38:39], v117
ds_read_b64_tr_b16 v[48:49], v116 offset:8
ds_read_b64_tr_b16 v[50:51], v117 offset:8
ds_read_b64_tr_b16 v[40:41], v118
ds_read_b64_tr_b16 v[42:43], v119
ds_read_b64_tr_b16 v[52:53], v118 offset:8
ds_read_b64_tr_b16 v[54:55], v119 offset:8
s_waitcnt lgkmcnt(8)
v_mfma_f32_16x16x32_bf16 v[120:123], v[32:35], v[64:67], 0
v_mfma_f32_16x16x32_bf16 v[132:135], v[32:35], v[68:71], 0
v_mfma_f32_16x16x32_bf16 v[120:123], v[44:47], v[72:75], v[120:123]
v_mfma_f32_16x16x32_bf16 v[132:135], v[44:47], v[76:79], v[132:135]
s_waitcnt lgkmcnt(4)
v_mfma_f32_16x16x32_bf16 v[124:127], v[36:39], v[64:67], 0
v_mfma_f32_16x16x32_bf16 v[136:139], v[36:39], v[68:71], 0
v_mfma_f32_16x16x32_bf16 v[124:127], v[48:51], v[72:75], v[124:127]
v_mfma_f32_16x16x32_bf16 v[136:139], v[48:51], v[76:79], v[136:139]
s_waitcnt lgkmcnt(0)
v_mfma_f32_16x16x32_bf16 v[128:131], v[40:43], v[64:67], 0
v_mfma_f32_16x16x32_bf16 v[140:143], v[40:43], v[68:71], 0
v_mfma_f32_16x16x32_bf16 v[128:131], v[52:55], v[72:75], v[128:131]
v_mfma_f32_16x16x32_bf16 v[140:143], v[52:55], v[76:79], v[140:143]
s_setprio 0
v_mul_f32 v8, v120, v90
v_mul_f32 v9, v132, v90
v_fma_f32 v8, -v132, v102, v8
v_fmac_f32 v9, v120, v102
v_cvt_pk_bf16_f32 v16, v8, v9
v_mul_f32 v6, v124, v94
v_mul_f32 v7, v136, v94
v_fma_f32 v6, -v136, v106, v6
v_fmac_f32 v7, v124, v106
v_cvt_pk_bf16_f32 v17, v6, v7
v_mul_f32 v8, v128, v98
v_mul_f32 v9, v140, v98
v_fma_f32 v8, -v140, v110, v8
v_fmac_f32 v9, v128, v110
v_cvt_pk_bf16_f32 v18, v8, v9
v_mul_f32 v8, v121, v91
v_mul_f32 v9, v133, v91
v_fma_f32 v8, -v133, v103, v8
s_setprio 2
v_fmac_f32 v9, v121, v103
v_mfma_f32_16x16x32_bf16 v[32:35], v[16:19], v[82:85], 0
v_cvt_pk_bf16_f32 v20, v8, v9
v_mul_f32 v6, v125, v95
v_mul_f32 v7, v137, v95
v_fma_f32 v6, -v137, v107, v6
v_fmac_f32 v7, v125, v107
v_mfma_f32_16x16x32_bf16 v[36:39], v[16:19], v[86:89], 0
s_setprio 0
v_cvt_pk_bf16_f32 v21, v6, v7
v_mul_f32 v8, v129, v99
v_mul_f32 v9, v141, v99
v_fma_f32 v8, -v141, v111, v8
v_fmac_f32 v9, v129, v111
v_cvt_pk_bf16_f32 v22, v8, v9
v_mul_f32 v8, v122, v92
v_mul_f32 v9, v134, v92
v_fma_f32 v8, -v134, v104, v8
s_setprio 2
v_fmac_f32 v9, v122, v104
v_mfma_f32_16x16x32_bf16 v[40:43], v[20:23], v[82:85], 0
v_cvt_pk_bf16_f32 v24, v8, v9
v_mul_f32 v6, v126, v96
v_mul_f32 v7, v138, v96
v_fma_f32 v6, -v138, v108, v6
v_fmac_f32 v7, v126, v108
v_mfma_f32_16x16x32_bf16 v[44:47], v[20:23], v[86:89], 0
s_setprio 0
v_cvt_pk_bf16_f32 v25, v6, v7
v_mul_f32 v8, v130, v100
v_mul_f32 v9, v142, v100
v_fma_f32 v8, -v142, v112, v8
v_fmac_f32 v9, v130, v112
v_cvt_pk_bf16_f32 v26, v8, v9
v_mul_f32 v8, v123, v93
v_mul_f32 v9, v135, v93
v_fma_f32 v8, -v135, v105, v8
s_setprio 2
v_fmac_f32 v9, v123, v105
v_mfma_f32_16x16x32_bf16 v[48:51], v[24:27], v[82:85], 0
v_cvt_pk_bf16_f32 v28, v8, v9
v_mul_f32 v6, v127, v97
v_mul_f32 v7, v139, v97
v_fma_f32 v6, -v139, v109, v6
v_fmac_f32 v7, v127, v109
v_mfma_f32_16x16x32_bf16 v[52:55], v[24:27], v[86:89], 0
s_setprio 0
v_cvt_pk_bf16_f32 v29, v6, v7
v_mul_f32 v8, v131, v101
v_mul_f32 v9, v143, v101
v_fma_f32 v8, -v143, v113, v8
v_fmac_f32 v9, v131, v113
s_setprio 2
v_cvt_pk_bf16_f32 v30, v8, v9
s_nop 1
v_mfma_f32_16x16x32_bf16 v[56:59], v[28:31], v[82:85], 0
v_mfma_f32_16x16x32_bf16 v[60:63], v[28:31], v[86:89], 0
ds_write_b128 v12, v[32:35] offset:10752
ds_write_b128 v12, v[40:43] offset:13632
ds_write_b128 v12, v[48:51] offset:16512
s_nop 3
ds_write_b128 v12, v[56:59] offset:19392
s_mov_b32 exec_lo, 0xf000f
s_mov_b32 exec_hi, 0xf000f
ds_write_b128 v12, v[36:39] offset:13056
ds_write_b128 v12, v[44:47] offset:15936
ds_write_b128 v12, v[52:55] offset:18816
ds_write_b128 v12, v[60:63] offset:21696
s_mov_b64 exec, -1
s_waitcnt lgkmcnt(0)
s_barrier
ds_read_b128 v[32:35], v13 offset:10752
ds_read_b128 v[36:39], v13 offset:10768
ds_read_b128 v[40:43], v13 offset:22272
ds_read_b128 v[44:47], v13 offset:22288
s_waitcnt lgkmcnt(0)
s_setprio 0
v_add_f32 v6, v32, v40
v_add_f32 v7, v33, v41
v_sub_f32 v8, v32, v40
v_sub_f32 v9, v33, v41
v_cvt_pk_bf16_f32 v16, v6, v7
v_cvt_pk_bf16_f32 v20, v8, v9
v_add_f32 v6, v34, v42
v_add_f32 v7, v35, v43
v_sub_f32 v8, v34, v42
v_sub_f32 v9, v35, v43
v_cvt_pk_bf16_f32 v17, v6, v7
v_cvt_pk_bf16_f32 v21, v8, v9
v_add_f32 v6, v36, v44
v_add_f32 v7, v37, v45
v_sub_f32 v8, v36, v44
v_sub_f32 v9, v37, v45
v_cvt_pk_bf16_f32 v18, v6, v7
v_cvt_pk_bf16_f32 v22, v8, v9
v_add_f32 v6, v38, v46
v_add_f32 v7, v39, v47
v_sub_f32 v8, v38, v46
v_sub_f32 v9, v39, v47
v_cvt_pk_bf16_f32 v19, v6, v7
s_setprio 2
v_cvt_pk_bf16_f32 v23, v8, v9
buffer_store_dwordx4 v[16:19], v80, s[28:31], s44 offen sc1
buffer_store_dwordx4 v[20:23], v80, s[28:31], s45 offen sc1
s_cmp_lg_u32 s24, 3
s_cbranch_scc1 r2x_38
ds_read_b128 v[48:51], v14 offset:13056
ds_read_b128 v[52:55], v14 offset:13072
ds_read_b128 v[56:59], v14 offset:24576
ds_read_b128 v[60:63], v14 offset:24592
s_waitcnt lgkmcnt(0)
s_setprio 0
v_add_f32 v6, v48, v56
v_add_f32 v7, v49, v57
v_sub_f32 v8, v48, v56
v_sub_f32 v9, v49, v57
v_cvt_pk_bf16_f32 v24, v6, v7
v_cvt_pk_bf16_f32 v28, v8, v9
v_add_f32 v6, v50, v58
v_add_f32 v7, v51, v59
v_sub_f32 v8, v50, v58
v_sub_f32 v9, v51, v59
v_cvt_pk_bf16_f32 v25, v6, v7
v_cvt_pk_bf16_f32 v29, v8, v9
v_add_f32 v6, v52, v60
v_add_f32 v7, v53, v61
v_sub_f32 v8, v52, v60
v_sub_f32 v9, v53, v61
v_cvt_pk_bf16_f32 v26, v6, v7
v_cvt_pk_bf16_f32 v30, v8, v9
v_add_f32 v6, v54, v62
v_add_f32 v7, v55, v63
v_sub_f32 v8, v54, v62
v_sub_f32 v9, v55, v63
v_cvt_pk_bf16_f32 v27, v6, v7
s_setprio 2
v_cvt_pk_bf16_f32 v31, v8, v9
buffer_store_dwordx4 v[24:27], v81, s[28:31], s42 offen sc1
buffer_store_dwordx4 v[28:31], v81, s[28:31], s42 offen offset:128 sc1
r2x_38:
s_waitcnt vmcnt(0)
s_barrier
s_cmp_lg_u32 s24, 0
s_cbranch_scc1 f3_39
s_lshr_b32 s37, s27, 3
s_lshl_b32 s37, s37, 2
s_and_b32 s3, s27, 3
s_add_u32 s37, s37, s3
s_mov_b32 s3, 1
s_lshl_b32 s38, s37, 8
s_add_u32 s38, s38, 18874432
s_atomic_add s3, s[22:23], s38
f3_39:
L_end:
s_endpgm
.p2align 6
T_P:
s_branch T_R
S_P:
L_prep:
s_sub_u32 s44, s25, 160
s_mov_b64 s[40:41], s[16:17]
s_mov_b32 s42, 1966080
s_mov_b32 s43, 0x00020000
s_lshr_b32 s46, s44, 1
s_lshl_b32 s46, s46, 2
s_add_u32 s46, s46, s24
s_lshl_b32 s46, s46, 4
s_and_b32 s47, s44, 1
s_add_u32 s46, s46, s47
s_mul_i32 s46, s46, 640
s_mul_i32 s47, s24, 5120
v_add_u32 v212, 0, v1
v_mul_u32_u24 v213, 1639, v212
v_lshrrev_b32 v213, 16, v213
v_mul_u32_u24 v213, 40, v213
v_add_lshl_u32 v212, v212, v213, 4
s_add_u32 m0, s47, 49152
s_nop 0
buffer_load_dwordx4 v212, s[40:43], s46 offen lds
v_add_u32 v212, 64, v1
v_mul_u32_u24 v213, 1639, v212
v_lshrrev_b32 v213, 16, v213
v_mul_u32_u24 v213, 40, v213
v_add_lshl_u32 v212, v212, v213, 4
s_add_u32 m0, s47, 50176
s_nop 0
buffer_load_dwordx4 v212, s[40:43], s46 offen lds
v_add_u32 v212, 128, v1
v_mul_u32_u24 v213, 1639, v212
v_lshrrev_b32 v213, 16, v213
v_mul_u32_u24 v213, 40, v213
v_add_lshl_u32 v212, v212, v213, 4
s_add_u32 m0, s47, 51200
s_nop 0
buffer_load_dwordx4 v212, s[40:43], s46 offen lds
v_add_u32 v212, 192, v1
v_mul_u32_u24 v213, 1639, v212
v_lshrrev_b32 v213, 16, v213
v_mul_u32_u24 v213, 40, v213
v_add_lshl_u32 v212, v212, v213, 4
s_add_u32 m0, s47, 52224
s_nop 0
buffer_load_dwordx4 v212, s[40:43], s46 offen lds
v_add_u32 v212, 256, v1
v_mul_u32_u24 v213, 1639, v212
v_lshrrev_b32 v213, 16, v213
v_mul_u32_u24 v213, 40, v213
v_add_lshl_u32 v212, v212, v213, 4
s_add_u32 m0, s47, 53248
s_nop 0
buffer_load_dwordx4 v212, s[40:43], s46 offen lds
s_waitcnt vmcnt(5)
s_barrier
s_mov_b32 s37, 100000
tag_26:
v_readfirstlane_b32 s36, v3
s_nop 1
s_cmp_lg_u32 s36, 0
s_cbranch_scc1 tag_27
s_sleep 8
buffer_load_dword v3, off, s[32:35], 0 sc1
s_waitcnt vmcnt(0)
s_sub_u32 s37, s37, 1
s_cbranch_scc0 tag_26
tag_27:
s_cmp_lg_u32 s24, 0
s_cbranch_scc1 arr_25
s_lshl_b32 s37, s26, 7
s_add_u32 s38, s37, 19009536
s_mov_b32 s3, 1
s_atomic_add s3, s[22:23], s38 glc
s_waitcnt lgkmcnt(0)
s_cmp_lg_u32 s3, 31
s_cbranch_scc1 arr_25
s_add_u32 s38, s37, 19038208
v_lshlrev_b32 v2, 5, v4
s_mov_b32 exec_hi, 0xff
buffer_store_dword v3, v2, s[28:31], s38 offen sc1
s_mov_b64 exec, -1
arr_25:
s_waitcnt vmcnt(0)
s_barrier
v_lshrrev_b32_e64 v212, 5, v1
v_bfe_u32 v213, v1, 2, 3
v_lshl_add_u32 v212, v212, 4, v213
v_mul_u32_u24 v212, 640, v212
v_and_b32 v213, 3, v1
v_lshl_add_u32 v212, v213, 3, v212
s_mul_i32 s46, s24, 160
v_add_u32 v212, s46, v212
ds_read_b64_tr_b16 v[6:7], v212 offset:49152
ds_read_b64_tr_b16 v[8:9], v212 offset:54272
ds_read_b64_tr_b16 v[10:11], v212 offset:49184
ds_read_b64_tr_b16 v[12:13], v212 offset:54304
ds_read_b64_tr_b16 v[14:15], v212 offset:49216
ds_read_b64_tr_b16 v[16:17], v212 offset:54336
ds_read_b64_tr_b16 v[18:19], v212 offset:49248
ds_read_b64_tr_b16 v[20:21], v212 offset:54368
ds_read_b64_tr_b16 v[22:23], v212 offset:49280
ds_read_b64_tr_b16 v[24:25], v212 offset:54400
v_lshlrev_b32 v34, 4, v1
s_and_b32 s46, s44, 1
s_lshl_b32 s46, s46, 2
s_add_u32 s46, s46, s24
s_mul_i32 s46, s46, 5
s_lshr_b32 s44, s44, 1
s_lshl_b32 s44, s44, 12
s_add_u32 s44, s44, 16777216
s_lshr_b32 s47, s46, 2
s_mul_i32 s47, s47, 188
s_add_u32 s47, s47, s46
s_lshl_b32 s47, s47, 10
s_add_u32 s47, s47, s44
s_waitcnt lgkmcnt(8)
buffer_store_dwordx4 v[6:9], v34, s[28:31], s47 offen sc1
s_add_u32 s46, s46, 1
s_lshr_b32 s47, s46, 2
s_mul_i32 s47, s47, 188
s_add_u32 s47, s47, s46
s_lshl_b32 s47, s47, 10
s_add_u32 s47, s47, s44
s_waitcnt lgkmcnt(6)
buffer_store_dwordx4 v[10:13], v34, s[28:31], s47 offen sc1
s_add_u32 s46, s46, 1
s_lshr_b32 s47, s46, 2
s_mul_i32 s47, s47, 188
s_add_u32 s47, s47, s46
s_lshl_b32 s47, s47, 10
s_add_u32 s47, s47, s44
s_waitcnt lgkmcnt(4)
buffer_store_dwordx4 v[14:17], v34, s[28:31], s47 offen sc1
s_add_u32 s46, s46, 1
s_lshr_b32 s47, s46, 2
s_mul_i32 s47, s47, 188
s_add_u32 s47, s47, s46
s_lshl_b32 s47, s47, 10
s_add_u32 s47, s47, s44
s_waitcnt lgkmcnt(2)
buffer_store_dwordx4 v[18:21], v34, s[28:31], s47 offen sc1
s_add_u32 s46, s46, 1
s_lshr_b32 s47, s46, 2
s_mul_i32 s47, s47, 188
s_add_u32 s47, s47, s46
s_lshl_b32 s47, s47, 10
s_add_u32 s47, s47, s44
s_waitcnt lgkmcnt(0)
buffer_store_dwordx4 v[22:25], v34, s[28:31], s47 offen sc1
s_waitcnt vmcnt(0)
s_barrier
s_cmp_lg_u32 s24, 0
s_cbranch_scc1 arr_28
s_lshl_b32 s37, s26, 7
s_add_u32 s38, s37, 19010560
s_mov_b32 s3, 1
s_atomic_add s3, s[22:23], s38 glc
s_waitcnt lgkmcnt(0)
s_cmp_lg_u32 s3, 11
s_cbranch_scc1 arr_28
s_add_u32 s38, s37, 19039232
v_lshlrev_b32 v2, 5, v4
s_mov_b32 exec_hi, 0xff
s_mov_b32 exec_lo, 0
buffer_store_dword v3, v2, s[28:31], s38 offen sc1
s_mov_b64 exec, -1
arr_28:
s_branch r2_23
.p2align 12
S_A1:
v_mul_f32 v29, 0xbd4ccccd, v26
v_mul_f32 v28, 0x41000000, v27
v_mul_f32 v28, v28, v29
v_cos_f32 v6, v28
v_sin_f32 v8, v28
v_add_f32 v28, v28, v29
v_cos_f32 v7, v28
v_sin_f32 v9, v28
v_add_f32 v28, v28, v29
v_cvt_pk_bf16_f32 v30, v6, v7
v_cvt_pk_bf16_f32 v34, v8, v9
v_cos_f32 v6, v28
v_sin_f32 v8, v28
v_add_f32 v28, v28, v29
v_cos_f32 v7, v28
v_sin_f32 v9, v28
v_add_f32 v28, v28, v29
v_cvt_pk_bf16_f32 v31, v6, v7
v_cvt_pk_bf16_f32 v35, v8, v9
v_cos_f32 v6, v28
v_sin_f32 v8, v28
v_add_f32 v28, v28, v29
v_cos_f32 v7, v28
v_sin_f32 v9, v28
v_add_f32 v28, v28, v29
v_cvt_pk_bf16_f32 v32, v6, v7
v_cvt_pk_bf16_f32 v36, v8, v9
v_cos_f32 v6, v28
v_sin_f32 v8, v28
v_add_f32 v28, v28, v29
v_cos_f32 v7, v28
v_sin_f32 v9, v28
v_cvt_pk_bf16_f32 v33, v6, v7
v_cvt_pk_bf16_f32 v37, v8, v9
v_mul_f32 v29, 0x3d000000, v26
v_mul_f32 v27, 4.0, v27
v_mul_f32 v28, v27, v29
v_cos_f32 v6, v28
v_sin_f32 v8, v28
v_add_f32 v28, v28, v29
v_cos_f32 v7, v28
v_sin_f32 v9, v28
v_add_f32 v28, v28, v29
v_cvt_pk_bf16_f32 v38, v6, v7
v_cvt_pk_bf16_f32 v42, v8, v9
v_cos_f32 v6, v28
v_sin_f32 v8, v28
v_add_f32 v28, v28, v29
v_cos_f32 v7, v28
v_sin_f32 v9, v28
v_cvt_pk_bf16_f32 v39, v6, v7
v_cvt_pk_bf16_f32 v43, v8, v9
s_mov_b32 exec_lo, 0x0
s_mov_b32 exec_hi, 0xffffffff
v_mov_b32 v32, 0
v_mov_b32 v33, 0
v_mov_b32 v36, 0
v_mov_b32 v37, 0
s_mov_b32 exec_hi, 0xffff0000
v_mov_b32 v30, 0
v_mov_b32 v31, 0
v_mov_b32 v34, 0
v_mov_b32 v35, 0
s_mov_b64 exec, -1
v_and_b32 v6, 1, v25
v_mul_u32_u24 v6, 0x8000, v6
v_lshl_or_b32 v6, v6, 16, v6
v_xor_b32 v40, v38, v6
v_xor_b32 v44, v42, v6
v_xor_b32 v41, v39, v6
v_xor_b32 v45, v43, v6
s_mov_b32 s56, 0x80008000
s_brev_b32 s57, 1
s_mov_b32 s58, 0x8000
v_xor_b32 v46, s56, v42
v_xor_b32 v50, s57, v38
v_xor_b32 v54, s57, v42
v_xor_b32 v58, s58, v38
v_xor_b32 v47, s56, v43
v_xor_b32 v51, s57, v39
v_xor_b32 v55, s57, v43
v_xor_b32 v59, s58, v39
v_xor_b32 v48, s56, v44
v_xor_b32 v52, s57, v40
v_xor_b32 v56, s57, v44
v_xor_b32 v60, s58, v40
v_xor_b32 v49, s56, v45
v_xor_b32 v53, s57, v41
v_xor_b32 v57, s57, v45
v_xor_b32 v61, s58, v41
s_lshr_b32 s57, s24, 1
s_mul_i32 s56, s60, s57
v_cvt_f32_u32_e64 v6, s56
v_mul_f32 v6, 0xba000000, v6
v_mul_f32 v29, 0xbacccccd, v26
v_fma_f32 v28, v27, v29, v6
v_mul_f32 v7, 0x41500000, v29
v_cos_f32 v62, v28
v_sin_f32 v70, v28
v_add_f32 v28, v28, v29
v_cos_f32 v63, v28
v_sin_f32 v71, v28
v_add_f32 v28, v28, v29
v_cos_f32 v64, v28
v_sin_f32 v72, v28
v_add_f32 v28, v28, v29
v_cos_f32 v65, v28
v_sin_f32 v73, v28
v_add_f32 v28, v28, v7
v_cos_f32 v66, v28
v_sin_f32 v74, v28
v_add_f32 v28, v28, v29
v_cos_f32 v67, v28
v_sin_f32 v75, v28
v_add_f32 v28, v28, v29
v_cos_f32 v68, v28
v_sin_f32 v76, v28
v_add_f32 v28, v28, v29
v_cos_f32 v69, v28
v_sin_f32 v77, v28
s_mul_i32 s56, s24, 1280
v_add_u32 v84, s56, v22
v_add_u32 v85, s56, v23
v_bfe_u32 v82, v1, 2, 2
v_and_b32 v83, 3, v1
v_lshlrev_b32 v83, 3, v83
s_and_b32 s57, s24, 2
s_mul_i32 s57, s57, 1280
s_add_u32 s56, s56, s57
v_lshl_add_u32 v8, v82, 6, v83
v_add_u32 v8, s56, v8
v_lshlrev_b32 v6, 1, v24
v_add_u32 v7, 1, v6
v_min_u32 v6, 4, v6
v_min_u32 v7, 4, v7
v_lshl_add_u32 v86, v6, 8, v8
v_lshl_add_u32 v87, v7, 8, v8
s_lshr_b32 s56, s24, 1
s_mul_i32 s56, s56, 5120
s_and_b32 s57, s24, 1
s_lshl_b32 s57, s57, 3
s_add_u32 s56, s56, s57
s_add_u32 s57, s56, 26928
s_add_u32 s56, s56, 22768
v_mul_u32_u24 v6, 80, v24
v_add_lshl_u32 v6, v6, v25, 4
v_add_u32 v88, s56, v6
v_sub_u32 v89, s57, v6
v_lshlrev_b32 v90, 1, v0
v_add_u32 v90, 658, v90
v_lshlrev_b32 v93, 4, v0
s_mul_i32 s69, s27, 20608
s_add_u32 s69, s69, 20971520
v_lshrrev_b32_e64 v6, 3, v0
v_bfe_u32 v7, v0, 2, 1
v_mul_u32_u24 v7, 1280, v7
v_lshl_add_u32 v6, v6, 3, v7
v_lshlrev_b32_e64 v6, 3, v6
v_lshl_add_u32 v94, v83, 1, v6
v_add_u32 v6, 4294967232, v0
v_mul_u32_u24 v7, 3277, v6
v_lshrrev_b32 v7, 16, v7
v_mul_u32_u24 v7, 20, v7
v_sub_u32 v7, v6, v7
v_subrev_u32 v7, 10, v7
v_cmp_gt_u32 vcc, 9, v7
v_lshl_add_u32 v8, v6, 1, 16
v_add_u32 v9, 1284, v8
v_cndmask_b32 v91, v9, v8, vcc
v_add_u32 v9, 512, v90
v_cmp_gt_u32 vcc, 64, v0
s_nop 1
v_cndmask_b32 v91, v91, v9, vcc
v_add_u32 v6, 192, v0
v_mul_u32_u24 v7, 3277, v6
v_lshrrev_b32 v7, 16, v7
v_mul_u32_u24 v7, 20, v7
v_sub_u32 v7, v6, v7
v_subrev_u32 v7, 10, v7
v_cmp_gt_u32 vcc, 9, v7
v_lshl_add_u32 v8, v6, 1, 16
v_add_u32 v9, 1284, v8
v_cndmask_b32 v92, v9, v8, vcc
v_cmp_eq_u32 vcc, 127, v0
s_nop 1
v_cndmask_b32 v92, v92, v8, vcc
v_and_b32 v8, 1, v1
v_lshlrev_b32 v8, 4, v8
v_mov_b32 v9, 0x3f80
v_lshlrev_b32 v8, v8, v9
v_lshrrev_b32 v7, 1, v25
v_cmp_eq_u32 vcc, 0, v7
s_nop 1
v_cndmask_b32 v232, 0, v8, vcc
v_cmp_eq_u32 vcc, 1, v7
s_nop 1
v_cndmask_b32 v233, 0, v8, vcc
v_cmp_eq_u32 vcc, 2, v7
s_nop 1
v_cndmask_b32 v234, 0, v8, vcc
v_cmp_eq_u32 vcc, 3, v7
s_nop 1
v_cndmask_b32 v235, 0, v8, vcc
v_lshl_add_u32 v7, v25, 1, v24
s_lshl_b32 s56, s24, 9
v_lshl_add_u32 v240, v7, 4, s56
s_sub_u32 s56, s25, 16
s_cmp_lt_u32 s25, 240
s_cselect_b32 s59, s25, s56
s_bitcmp0_b32 s59, 0
s_cselect_b64 s[64:65], s[12:13], s[14:15]
s_cselect_b32 s68, 0, 6144
s_cmp_lt_u32 s25, 240
s_cselect_b32 s66, 1966080, 0
s_cselect_b32 s68, s68, 0x40000000
s_mov_b32 s67, 0x00020000
s_lshr_b32 s57, s59, 3
s_mul_i32 s56, s57, 52
s_lshr_b32 s56, s56, 8
s_mul_i32 s61, s56, 5
s_sub_u32 s57, s57, s61
s_and_b32 s59, s59, 6
s_lshl_b32 s61, s59, 1
s_lshr_b32 s61, 0x3115, s61
s_and_b32 s61, s61, 15
s_add_u32 s56, s56, s61
s_sub_u32 s61, s56, 6
s_cselect_b32 s56, s56, s61
s_mul_i32 s59, s59, 3
s_add_u32 s59, s59, s56
s_mul_i32 s56, s57, 12288
s_add_u32 s68, s68, s56
s_lshl_b32 s56, s59, 8
s_add_u32 s68, s68, s56
s_add_u32 s68, s68, 18939904
s_lshl_b32 s56, s57, 2
s_add_u32 s56, s56, s24
s_mul_i32 s56, s56, 98304
s_lshl_b32 s59, s59, 7
s_add_u32 s56, s56, s59
v_lshrrev_b32 v6, 3, v1
v_mul_u32_u24 v6, 3072, v6
v_and_b32 v7, 0x70, v22
v_add_u32 v6, v6, v7
buffer_load_dwordx4 v[216:219], v6, s[64:67], s56 offen
s_add_u32 s56, s56, 24576
buffer_load_dwordx4 v[220:223], v6, s[64:67], s56 offen
s_add_u32 s56, s56, 24576
buffer_load_dwordx4 v[224:227], v6, s[64:67], s56 offen
s_add_u32 s56, s56, 24576
buffer_load_dwordx4 v[228:231], v6, s[64:67], s56 offen
s_branch S_A2
.p2align 6
T_F:
s_branch L_touched
S_F:
s_waitcnt vmcnt(3)
v_lshlrev_b32 v196, 16, v76
v_and_b32 v197, s48, v76
v_lshlrev_b32 v198, 16, v77
v_and_b32 v199, s48, v77
v_lshlrev_b32 v200, 16, v78
v_and_b32 v201, s48, v78
v_lshlrev_b32 v202, 16, v79
v_and_b32 v203, s48, v79
v_lshlrev_b32 v204, 16, v80
v_and_b32 v205, s48, v80
v_lshlrev_b32 v206, 16, v81
v_and_b32 v207, s48, v81
v_lshlrev_b32 v208, 16, v82
v_and_b32 v209, s48, v82
v_lshlrev_b32 v210, 16, v83
v_and_b32 v211, s48, v83
v_lshlrev_b32 v212, 16, v84
v_and_b32 v213, s48, v84
v_lshlrev_b32 v214, 16, v85
v_and_b32 v215, s48, v85
s_waitcnt lgkmcnt(0)
s_barrier
ds_read_b128 v[116:119], v249 offset:0
ds_read_b128 v[120:123], v249 offset:256
ds_read_b128 v[124:127], v249 offset:20480
ds_read_b128 v[128:131], v249 offset:20736
ds_read_b128 v[132:135], v249 offset:40960
ds_read_b128 v[136:139], v249 offset:41216
ds_read_b128 v[140:143], v249 offset:61440
ds_read_b128 v[144:147], v249 offset:61696
ds_read_b128 v[180:183], v250 offset:0
ds_read_b128 v[184:187], v250 offset:20480
ds_read_b128 v[188:191], v250 offset:40960
ds_read_b128 v[192:195], v250 offset:61440
s_waitcnt lgkmcnt(4)
s_nop 0
ds_read_b128 v[148:151], v6 offset:0
ds_read_b128 v[152:155], v6 offset:256
ds_read_b128 v[156:159], v6 offset:20480
ds_read_b128 v[160:163], v6 offset:20736
ds_read_b128 v[164:167], v6 offset:40960
ds_read_b128 v[168:171], v6 offset:41216
ds_read_b128 v[172:175], v6 offset:61440
ds_read_b128 v[176:179], v6 offset:61696
v_pk_add_f32 v[116:117], v[116:117], v[124:125]
v_pk_add_f32 v[132:133], v[132:133], v[140:141]
v_pk_add_f32 v[118:119], v[118:119], v[126:127]
v_pk_add_f32 v[134:135], v[134:135], v[142:143]
v_pk_add_f32 v[120:121], v[120:121], v[128:129]
v_pk_add_f32 v[136:137], v[136:137], v[144:145]
v_pk_add_f32 v[122:123], v[122:123], v[130:131]
v_pk_add_f32 v[138:139], v[138:139], v[146:147]
v_pk_add_f32 v[116:117], v[116:117], v[132:133]
v_pk_add_f32 v[118:119], v[118:119], v[134:135]
v_pk_add_f32 v[120:121], v[120:121], v[136:137]
v_pk_add_f32 v[122:123], v[122:123], v[138:139]
v_pk_mul_f32 v[96:97], v[116:117], v[8:9]
v_pk_mul_f32 v[98:99], v[118:119], v[8:9]
v_pk_mul_f32 v[100:101], v[120:121], v[8:9]
v_pk_mul_f32 v[102:103], v[122:123], v[8:9]
v_exp_f32 v96, v96
v_exp_f32 v97, v97
v_exp_f32 v98, v98
v_exp_f32 v99, v99
v_exp_f32 v100, v100
v_exp_f32 v101, v101
v_exp_f32 v102, v102
v_exp_f32 v103, v103
v_pk_add_f32 v[96:97], v[96:97], 1.0 op_sel_hi:[1,0]
v_pk_add_f32 v[98:99], v[98:99], 1.0 op_sel_hi:[1,0]
v_pk_add_f32 v[100:101], v[100:101], 1.0 op_sel_hi:[1,0]
v_pk_add_f32 v[102:103], v[102:103], 1.0 op_sel_hi:[1,0]
v_rcp_f32 v96, v96
v_rcp_f32 v97, v97
v_rcp_f32 v98, v98
v_rcp_f32 v99, v99
v_rcp_f32 v100, v100
v_rcp_f32 v101, v101
v_rcp_f32 v102, v102
v_rcp_f32 v103, v103
s_waitcnt vmcnt(2)
v_lshlrev_b32 v104, 16, v86
v_and_b32 v105, s48, v86
v_lshlrev_b32 v106, 16, v87
v_and_b32 v107, s48, v87
v_lshlrev_b32 v108, 16, v88
v_and_b32 v109, s48, v88
v_lshlrev_b32 v110, 16, v89
v_and_b32_e64 v111, s48, v89
v_pk_mul_f32 v[116:117], v[116:117], v[96:97]
v_pk_mul_f32 v[118:119], v[118:119], v[98:99]
v_pk_mul_f32 v[120:121], v[120:121], v[100:101]
v_pk_mul_f32 v[122:123], v[122:123], v[102:103]
v_pk_fma_f32 v[116:117], v[116:117], v[104:105], v[196:197]
v_pk_fma_f32 v[118:119], v[118:119], v[106:107], v[198:199]
v_pk_fma_f32 v[120:121], v[120:121], v[108:109], v[200:201]
v_pk_fma_f32 v[122:123], v[122:123], v[110:111], v[202:203]
v_cvt_pk_bf16_f32 v76, v116, v117
v_cvt_pk_bf16_f32 v77, v118, v119
v_cvt_pk_bf16_f32 v78, v120, v121
v_cvt_pk_bf16_f32 v79, v122, v123
buffer_store_dwordx4 v[76:79], v251, s[44:47], s53 offen sc1
s_waitcnt lgkmcnt(0)
s_nop 0
v_pk_add_f32 v[148:149], v[148:149], v[156:157]
v_pk_add_f32 v[164:165], v[164:165], v[172:173]
v_pk_add_f32 v[150:151], v[150:151], v[158:159]
v_pk_add_f32 v[166:167], v[166:167], v[174:175]
v_pk_add_f32 v[152:153], v[152:153], v[160:161]
v_pk_add_f32 v[168:169], v[168:169], v[176:177]
v_pk_add_f32 v[154:155], v[154:155], v[162:163]
v_pk_add_f32 v[170:171], v[170:171], v[178:179]
v_pk_add_f32 v[148:149], v[148:149], v[164:165]
v_pk_add_f32 v[150:151], v[150:151], v[166:167]
v_pk_add_f32 v[152:153], v[152:153], v[168:169]
v_pk_add_f32 v[154:155], v[154:155], v[170:171]
v_pk_mul_f32 v[96:97], v[148:149], v[8:9]
v_pk_mul_f32 v[98:99], v[150:151], v[8:9]
v_pk_mul_f32 v[100:101], v[152:153], v[8:9]
v_pk_mul_f32 v[102:103], v[154:155], v[8:9]
v_exp_f32 v96, v96
v_exp_f32 v97, v97
v_exp_f32 v98, v98
v_exp_f32 v99, v99
v_exp_f32 v100, v100
v_exp_f32 v101, v101
v_exp_f32 v102, v102
v_exp_f32 v103, v103
v_pk_add_f32 v[96:97], v[96:97], 1.0 op_sel_hi:[1,0]
v_pk_add_f32 v[98:99], v[98:99], 1.0 op_sel_hi:[1,0]
v_pk_add_f32 v[100:101], v[100:101], 1.0 op_sel_hi:[1,0]
v_pk_add_f32 v[102:103], v[102:103], 1.0 op_sel_hi:[1,0]
v_rcp_f32 v96, v96
v_rcp_f32 v97, v97
v_rcp_f32 v98, v98
v_rcp_f32 v99, v99
v_rcp_f32 v100, v100
v_rcp_f32 v101, v101
v_rcp_f32 v102, v102
v_rcp_f32 v103, v103
s_waitcnt vmcnt(2)
v_lshlrev_b32 v104, 16, v90
v_and_b32 v105, s48, v90
v_lshlrev_b32 v106, 16, v91
v_and_b32 v107, s48, v91
v_lshlrev_b32 v108, 16, v92
v_and_b32 v109, s48, v92
v_lshlrev_b32 v110, 16, v93
v_and_b32_e64 v111, s48, v93
v_pk_mul_f32 v[148:149], v[148:149], v[96:97]
v_pk_mul_f32 v[150:151], v[150:151], v[98:99]
v_pk_mul_f32 v[152:153], v[152:153], v[100:101]
v_pk_mul_f32 v[154:155], v[154:155], v[102:103]
v_pk_fma_f32 v[148:149], v[148:149], v[104:105], v[204:205]
v_pk_fma_f32 v[150:151], v[150:151], v[106:107], v[206:207]
v_pk_fma_f32 v[152:153], v[152:153], v[108:109], v[208:209]
v_pk_fma_f32 v[154:155], v[154:155], v[110:111], v[210:211]
v_cvt_pk_bf16_f32 v80, v148, v149
v_cvt_pk_bf16_f32 v81, v150, v151
v_cvt_pk_bf16_f32 v82, v152, v153
v_cvt_pk_bf16_f32 v83, v154, v155
buffer_store_dwordx4 v[80:83], v251, s[44:47], s51 offen sc1
v_pk_add_f32 v[180:181], v[180:181], v[184:185]
v_pk_add_f32 v[188:189], v[188:189], v[192:193]
v_pk_add_f32 v[182:183], v[182:183], v[186:187]
v_pk_add_f32 v[190:191], v[190:191], v[194:195]
v_pk_add_f32 v[180:181], v[180:181], v[188:189]
v_pk_add_f32 v[182:183], v[182:183], v[190:191]
v_pk_mul_f32 v[96:97], v[180:181], v[8:9]
v_pk_mul_f32 v[98:99], v[182:183], v[8:9]
v_exp_f32 v96, v96
v_exp_f32 v97, v97
v_exp_f32 v98, v98
v_exp_f32 v99, v99
v_pk_add_f32 v[96:97], v[96:97], 1.0 op_sel_hi:[1,0]
v_pk_add_f32 v[98:99], v[98:99], 1.0 op_sel_hi:[1,0]
v_rcp_f32 v96, v96
v_rcp_f32 v97, v97
v_rcp_f32 v98, v98
v_rcp_f32 v99, v99
s_waitcnt vmcnt(2)
v_lshlrev_b32 v104, 16, v94
v_and_b32 v105, s48, v94
v_lshlrev_b32 v106, 16, v95
v_and_b32_e64 v107, s48, v95
v_pk_mul_f32 v[180:181], v[180:181], v[96:97]
v_pk_mul_f32 v[182:183], v[182:183], v[98:99]
v_pk_fma_f32 v[180:181], v[180:181], v[104:105], v[212:213]
v_pk_fma_f32 v[182:183], v[182:183], v[106:107], v[214:215]
v_cvt_pk_bf16_f32 v84, v180, v181
v_cvt_pk_bf16_f32 v85, v182, v183
buffer_store_dwordx2 v[84:85], v252, s[44:47], s56 offen offset:1024
s_endpgm
.p2align 12
S_M:
L_mid:
s_and_b32 s48, s25, 7
s_lshl_b32 s48, s48, 1
s_bfe_u32 s49, s25, 0x10003
s_add_u32 s48, s48, s49
s_mul_i32 s51, s48, 6
s_movk_i32 s50, 120
s_and_b32 s49, s25, 6
s_add_u32 s27, s48, s49
s_add_u32 s27, s27, 120
s_and_b32 s49, s24, 2
v_mul_u32_u24 v7, 171, v1
v_lshrrev_b32 v7, 11, v7
v_mul_u32_u24 v8, 12, v7
v_sub_u32 v6, v1, v8
v_xor_b32 v6, s49, v6
v_mul_u32_u24 v7, 192, v7
v_add_lshl_u32 v96, v7, v6, 4
v_add_u32 v6, 64, v1
v_mul_u32_u24 v7, 171, v6
v_lshrrev_b32 v7, 11, v7
v_mul_u32_u24 v8, 12, v7
v_sub_u32 v6, v6, v8
v_xor_b32_e64 v6, s49, v6
v_mul_u32_u24 v7, 192, v7
v_add_lshl_u32 v97, v7, v6, 4
v_add_u32 v6, 128, v1
v_mul_u32_u24 v7, 171, v6
v_lshrrev_b32 v7, 11, v7
v_mul_u32_u24 v8, 12, v7
v_sub_u32 v6, v6, v8
v_xor_b32 v6, s49, v6
v_mul_u32_u24 v7, 192, v7
v_add_lshl_u32 v98, v7, v6, 4
s_lshl_b32 s56, s52, 2
s_add_u32 s56, s56, s61
s_mul_i32 s56, s56, 49152
s_lshl_b32 s48, s51, 5
s_add_u32 s56, s56, s48
s_mul_i32 s60, s24, 3072
s_mul_i32 s59, s24, 4
s_add_u32 s48, s59, s50
s_lshr_b32 s49, s48, 5
s_mul_i32 s49, s49, 96
s_add_u32 s48, s48, s49
s_mul_i32 s48, s48, 10
s_add_u32 s48, s48, s52
s_lshl_b32 s53, s48, 7
s_add_u32 s48, s59, s50
s_add_u32 s48, s48, 2
s_lshr_b32 s49, s48, 5
s_mul_i32 s49, s49, 96
s_add_u32 s48, s48, s49
s_mul_i32 s48, s48, 10
s_add_u32 s48, s48, s52
s_lshl_b32 s54, s48, 7
s_lshl_b32 s59, s59, 10
s_waitcnt lgkmcnt(0)
s_mov_b64 s[28:29], s[22:23]
s_mov_b32 s30, 26738688
s_mov_b32 s31, 0x00020000
s_mov_b64 s[32:33], s[20:21]
s_mov_b32 s34, 256
s_mov_b32 s35, 0x00020000
s_mov_b64 s[40:41], s[4:5]
s_mov_b32 s42, 2621440
s_mov_b32 s43, 0x00020000
s_cmp_lt_u32 s24, 2
s_cselect_b64 s[44:45], s[12:13], s[14:15]
s_mov_b32 s46, 1966080
s_mov_b32 s47, 0x00020000
s_add_u32 m0, s60, 0
s_nop 0
buffer_load_dwordx4 v96, s[44:47], s56 offen lds
s_add_u32 m0, s60, 1024
s_nop 0
buffer_load_dwordx4 v97, s[44:47], s56 offen lds
s_add_u32 m0, s60, 2048
s_nop 0
buffer_load_dwordx4 v98, s[44:47], s56 offen lds
s_add_u32 m0, s59, 49152
s_nop 0
buffer_load_dwordx4 v100, s[40:43], s53 offen lds
s_add_u32 m0, s59, 50176
s_nop 0
buffer_load_dwordx4 v101, s[40:43], s53 offen lds
s_add_u32 m0, s59, 51200
s_nop 0
buffer_load_dwordx4 v100, s[40:43], s54 offen lds
s_add_u32 m0, s59, 52224
s_nop 0
buffer_load_dwordx4 v101, s[40:43], s54 offen lds
v_and_b32 v6, 31, v1
v_lshrrev_b32 v7, 5, v1
v_bfe_u32 v8, v1, 1, 3
v_xor_b32 v8, v8, v7
s_mul_i32 s48, s62, 8192
s_add_u32 s48, s48, 49152
v_lshlrev_b32 v6, 7, v6
v_add_u32 v6, s48, v6
v_lshl_add_u32 v252, v8, 4, v6
v_xor_b32 v253, 32, v252
v_xor_b32 v254, 64, v252
v_xor_b32 v255, 96, v252
v_bfe_u32 v6, v1, 2, 2
v_lshl_add_u32 v6, v7, 3, v6
v_bfe_u32 v8, v1, 4, 1
v_lshl_add_u32 v6, v8, 5, v6
v_mul_u32_u24 v6, 192, v6
v_and_b32 v9, 3, v1
v_lshl_add_u32 v6, v9, 3, v6
s_mul_i32 s48, s61, 3
s_add_u32 s49, s48, 1
v_xor_b32 v9, s48, v8
v_lshl_add_u32 v102, v9, 5, v6
v_xor_b32 v9, s49, v8
v_lshl_add_u32 v103, v9, 5, v6
v_mov_b64 v[116:117], 0
v_mov_b64 v[118:119], 0
v_mov_b64 v[120:121], 0
v_mov_b64 v[122:123], 0
v_mov_b64 v[124:125], 0
v_mov_b64 v[126:127], 0
v_mov_b64 v[128:129], 0
v_mov_b64 v[130:131], 0
v_mov_b64 v[132:133], 0
v_mov_b64 v[134:135], 0
v_mov_b64 v[136:137], 0
v_mov_b64 v[138:139], 0
v_mov_b64 v[140:141], 0
v_mov_b64 v[142:143], 0
v_mov_b64 v[144:145], 0
v_mov_b64 v[146:147], 0
v_mov_b64 v[148:149], 0
v_mov_b64 v[150:151], 0
v_mov_b64 v[152:153], 0
v_mov_b64 v[154:155], 0
v_mov_b64 v[156:157], 0
v_mov_b64 v[158:159], 0
v_mov_b64 v[160:161], 0
v_mov_b64 v[162:163], 0
v_mov_b64 v[164:165], 0
v_mov_b64 v[166:167], 0
v_mov_b64 v[168:169], 0
v_mov_b64 v[170:171], 0
v_mov_b64 v[172:173], 0
v_mov_b64 v[174:175], 0
v_mov_b64 v[176:177], 0
v_mov_b64 v[178:179], 0
v_mov_b64 v[180:181], 0
v_mov_b64 v[182:183], 0
v_mov_b64 v[184:185], 0
v_mov_b64 v[186:187], 0
v_mov_b64 v[188:189], 0
v_mov_b64 v[190:191], 0
v_mov_b64 v[192:193], 0
v_mov_b64 v[194:195], 0
v_mov_b64 v[196:197], 0
v_mov_b64 v[198:199], 0
v_mov_b64 v[200:201], 0
v_mov_b64 v[202:203], 0
v_mov_b64 v[204:205], 0
v_mov_b64 v[206:207], 0
v_mov_b64 v[208:209], 0
v_mov_b64 v[210:211], 0
v_mov_b64 v[232:233], 0
v_mov_b64 v[234:235], 0
v_mov_b64 v[236:237], 0
v_mov_b64 v[238:239], 0
v_mov_b64 v[240:241], 0
v_mov_b64 v[242:243], 0
v_mov_b64 v[84:85], 0
v_mov_b64 v[86:87], 0
v_mov_b64 v[88:89], 0
v_mov_b64 v[90:91], 0
s_lshl_b32 s48, s26, 2
s_bfe_u32 s49, s25, 0x20003
s_add_u32 s63, s48, s49
s_lshr_b32 s64, s25, 5
s_and_b32 s48, s26, 6
s_lshl_b32 s48, s48, 2
s_bfe_u32 s49, s25, 0x30003
s_add_u32 s63, s48, s49
s_and_b32 s48, s26, 1
s_lshl_b32 s48, s48, 2
s_lshr_b32 s49, s25, 6
s_add_u32 s64, s48, s49
s_min_u32 s48, s26, 5
s_lshl_b32 s65, s48, 13
s_mov_b32 s49, 49152
s_add_u32 s66, s65, 8192
s_cmp_eq_u32 s66, s49
s_cselect_b32 s66, 0, s66
s_add_u32 s67, s66, 8192
s_cmp_eq_u32 s67, s49
s_cselect_b32 s67, 0, s67
s_add_u32 s68, s67, 8192
s_cmp_eq_u32 s68, s49
s_cselect_b32 s68, 0, s68
s_add_u32 s69, s68, 8192
s_cmp_eq_u32 s69, s49
s_cselect_b32 s69, 0, s69
s_add_u32 s70, s69, 8192
s_cmp_eq_u32 s70, s49
s_cselect_b32 s70, 0, s70
s_add_u32 s71, s65, 4096
s_add_u32 s72, s66, 4096
s_add_u32 s73, s67, 4096
s_add_u32 s74, s68, 4096
s_add_u32 s75, s69, 4096
s_add_u32 s76, s70, 4096
s_mul_i32 s49, s24, s49
v_lshl_add_u32 v6, v1, 4, s49
s_mul_i32 s48, s63, 196608
s_add_u32 s48, s48, 10485760
v_add_u32 v10, s48, v6
s_mul_i32 s48, s64, 196608
s_add_u32 s48, s48, 16777216
v_add_u32 v11, s48, v6
s_lshr_b32 s48, s64, 2
s_mul_i32 s48, s48, 196608
s_and_b32 s49, s64, 3
s_lshl_b32 s49, s49, 10
s_add_u32 s48, s48, s49
s_add_u32 s48, s48, 18350080
v_add_u32 v12, s48, v6
s_add_u32 s57, s56, 98304
s_add_u32 m0, s60, 12288
s_nop 0
buffer_load_dwordx4 v96, s[44:47], s57 offen lds
s_add_u32 m0, s60, 13312
s_nop 0
buffer_load_dwordx4 v97, s[44:47], s57 offen lds
s_add_u32 m0, s60, 14336
s_nop 0
buffer_load_dwordx4 v98, s[44:47], s57 offen lds
s_movk_i32 s49, 128
s_add_u32 s52, s52, 1
s_cmp_eq_u32 s52, 10
s_cselect_b32 s52, 0, s52
s_cselect_b32 s48, 4294966144, s49
s_add_u32 s53, s53, s48
s_add_u32 s54, s54, s48
s_mul_i32 s48, s48, 1536
s_add_u32 s56, s56, s48
s_add_u32 m0, s59, 65536
s_nop 0
buffer_load_dwordx4 v100, s[40:43], s53 offen lds
s_add_u32 m0, s59, 66560
s_nop 0
buffer_load_dwordx4 v101, s[40:43], s53 offen lds
s_add_u32 m0, s60, 24576
s_nop 0
buffer_load_dwordx4 v96, s[44:47], s56 offen lds
s_add_u32 m0, s60, 25600
s_nop 0
buffer_load_dwordx4 v97, s[44:47], s56 offen lds
s_add_u32 m0, s60, 26624
s_nop 0
buffer_load_dwordx4 v98, s[44:47], s56 offen lds
s_mov_b32 s58, 4
s_waitcnt vmcnt(8)
g1loop_40:
s_barrier
v_mfma_f32_32x32x16_bf16 v[116:131], v[232:235], v[84:87], v[116:131]
ds_read_b64_tr_b16 v[212:213], v102 offset:0
ds_read_b64_tr_b16 v[214:215], v102 offset:768
ds_read_b128 v[224:227], v252 offset:0
s_add_u32 m0, s59, 67584
s_nop 0
buffer_load_dwordx4 v100, s[40:43], s54 offen lds
v_mfma_f32_32x32x16_bf16 v[132:147], v[232:235], v[88:91], v[132:147]
ds_read_b128 v[228:231], v252 offset:4096
ds_read_b64_tr_b16 v[216:217], v103 offset:0
ds_read_b64_tr_b16 v[218:219], v103 offset:768
v_mfma_f32_32x32x16_bf16 v[148:163], v[236:239], v[84:87], v[148:163]
ds_read_b64_tr_b16 v[220:221], v102 offset:64
ds_read_b64_tr_b16 v[222:223], v102 offset:832
s_add_u32 m0, s59, 68608
s_nop 0
buffer_load_dwordx4 v101, s[40:43], s54 offen lds
v_mfma_f32_32x32x16_bf16 v[164:179], v[236:239], v[88:91], v[164:179]
ds_read_b128 v[72:75], v254 offset:0
ds_read_b128 v[76:79], v254 offset:4096
v_mfma_f32_32x32x16_bf16 v[180:195], v[240:243], v[84:87], v[180:195]
s_add_u32 s57, s56, 98304
s_add_u32 m0, s60, 36864
s_nop 0
buffer_load_dwordx4 v96, s[44:47], s57 offen lds
v_mfma_f32_32x32x16_bf16 v[196:211], v[240:243], v[88:91], v[196:211]
s_waitcnt lgkmcnt(2)
v_mfma_f32_32x32x16_bf16 v[116:131], v[212:215], v[224:227], v[116:131]
ds_read_b64_tr_b16 v[232:233], v102 offset:3072
ds_read_b64_tr_b16 v[234:235], v102 offset:3840
ds_read_b128 v[244:247], v253 offset:0
v_mfma_f32_32x32x16_bf16 v[132:147], v[212:215], v[228:231], v[132:147]
ds_read_b128 v[248:251], v253 offset:4096
ds_read_b64_tr_b16 v[236:237], v103 offset:3072
ds_read_b64_tr_b16 v[238:239], v103 offset:3840
s_add_u32 m0, s60, 37888
s_nop 0
buffer_load_dwordx4 v97, s[44:47], s57 offen lds
v_mfma_f32_32x32x16_bf16 v[148:163], v[216:219], v[224:227], v[148:163]
ds_read_b64_tr_b16 v[240:241], v102 offset:3136
ds_read_b64_tr_b16 v[242:243], v102 offset:3904
v_mfma_f32_32x32x16_bf16 v[164:179], v[216:219], v[228:231], v[164:179]
ds_read_b128 v[84:87], v255 offset:0
ds_read_b128 v[88:91], v255 offset:4096
s_add_u32 m0, s60, 38912
s_nop 0
buffer_load_dwordx4 v98, s[44:47], s57 offen lds
v_mfma_f32_32x32x16_bf16 v[180:195], v[220:223], v[224:227], v[180:195]
v_mfma_f32_32x32x16_bf16 v[196:211], v[220:223], v[228:231], v[196:211]
s_waitcnt vmcnt(10) lgkmcnt(0)
s_barrier
v_mfma_f32_32x32x16_bf16 v[116:131], v[232:235], v[244:247], v[116:131]
ds_read_b64_tr_b16 v[212:213], v102 offset:12288
ds_read_b64_tr_b16 v[214:215], v102 offset:13056
ds_read_b64_tr_b16 v[216:217], v103 offset:12288
s_add_u32 s52, s52, 1
s_cmp_eq_u32 s52, 10
s_cselect_b32 s52, 0, s52
s_cselect_b32 s48, 4294966144, s49
s_add_u32 s53, s53, s48
s_add_u32 s54, s54, s48
s_mul_i32 s48, s48, 1536
s_add_u32 s56, s56, s48
s_add_u32 m0, s59, 49152
s_nop 0
buffer_load_dwordx4 v100, s[40:43], s53 offen lds
v_mfma_f32_32x32x16_bf16 v[132:147], v[232:235], v[248:251], v[132:147]
ds_read_b64_tr_b16 v[218:219], v103 offset:13056
ds_read_b64_tr_b16 v[220:221], v102 offset:12352
ds_read_b64_tr_b16 v[222:223], v102 offset:13120
v_mfma_f32_32x32x16_bf16 v[148:163], v[236:239], v[244:247], v[148:163]
s_add_u32 m0, s59, 50176
s_nop 0
buffer_load_dwordx4 v101, s[40:43], s53 offen lds
v_mfma_f32_32x32x16_bf16 v[164:179], v[236:239], v[248:251], v[164:179]
v_mfma_f32_32x32x16_bf16 v[180:195], v[240:243], v[244:247], v[180:195]
s_add_u32 m0, s60, 0
s_nop 0
buffer_load_dwordx4 v96, s[44:47], s56 offen lds
v_mfma_f32_32x32x16_bf16 v[196:211], v[240:243], v[248:251], v[196:211]
s_waitcnt lgkmcnt(0)
v_mfma_f32_32x32x16_bf16 v[116:131], v[212:215], v[72:75], v[116:131]
ds_read_b64_tr_b16 v[232:233], v102 offset:15360
ds_read_b64_tr_b16 v[234:235], v102 offset:16128
ds_read_b64_tr_b16 v[236:237], v103 offset:15360
v_mfma_f32_32x32x16_bf16 v[132:147], v[212:215], v[76:79], v[132:147]
ds_read_b64_tr_b16 v[238:239], v103 offset:16128
ds_read_b64_tr_b16 v[240:241], v102 offset:15424
ds_read_b64_tr_b16 v[242:243], v102 offset:16192
s_add_u32 m0, s60, 1024
s_nop 0
buffer_load_dwordx4 v97, s[44:47], s56 offen lds
v_mfma_f32_32x32x16_bf16 v[148:163], v[216:219], v[72:75], v[148:163]
v_mfma_f32_32x32x16_bf16 v[164:179], v[216:219], v[76:79], v[164:179]
s_add_u32 m0, s60, 2048
s_nop 0
buffer_load_dwordx4 v98, s[44:47], s56 offen lds
v_mfma_f32_32x32x16_bf16 v[180:195], v[220:223], v[72:75], v[180:195]
v_mfma_f32_32x32x16_bf16 v[196:211], v[220:223], v[76:79], v[196:211]
s_waitcnt vmcnt(8) lgkmcnt(0)
s_barrier
v_mfma_f32_32x32x16_bf16 v[116:131], v[232:235], v[84:87], v[116:131]
ds_read_b64_tr_b16 v[212:213], v102 offset:24576
ds_read_b64_tr_b16 v[214:215], v102 offset:25344
ds_read_b128 v[224:227], v252 offset:16384
s_add_u32 m0, s59, 51200
s_nop 0
buffer_load_dwordx4 v100, s[40:43], s54 offen lds
v_mfma_f32_32x32x16_bf16 v[132:147], v[232:235], v[88:91], v[132:147]
ds_read_b128 v[228:231], v252 offset:20480
ds_read_b64_tr_b16 v[216:217], v103 offset:24576
ds_read_b64_tr_b16 v[218:219], v103 offset:25344
v_mfma_f32_32x32x16_bf16 v[148:163], v[236:239], v[84:87], v[148:163]
ds_read_b64_tr_b16 v[220:221], v102 offset:24640
ds_read_b64_tr_b16 v[222:223], v102 offset:25408
s_add_u32 m0, s59, 52224
s_nop 0
buffer_load_dwordx4 v101, s[40:43], s54 offen lds
v_mfma_f32_32x32x16_bf16 v[164:179], v[236:239], v[88:91], v[164:179]
ds_read_b128 v[72:75], v254 offset:16384
ds_read_b128 v[76:79], v254 offset:20480
v_mfma_f32_32x32x16_bf16 v[180:195], v[240:243], v[84:87], v[180:195]
s_add_u32 s57, s56, 98304
s_add_u32 m0, s60, 12288
s_nop 0
buffer_load_dwordx4 v96, s[44:47], s57 offen lds
v_mfma_f32_32x32x16_bf16 v[196:211], v[240:243], v[88:91], v[196:211]
s_waitcnt lgkmcnt(2)
v_mfma_f32_32x32x16_bf16 v[116:131], v[212:215], v[224:227], v[116:131]
ds_read_b64_tr_b16 v[232:233], v102 offset:27648
ds_read_b64_tr_b16 v[234:235], v102 offset:28416
ds_read_b128 v[244:247], v253 offset:16384
v_mfma_f32_32x32x16_bf16 v[132:147], v[212:215], v[228:231], v[132:147]
ds_read_b128 v[248:251], v253 offset:20480
ds_read_b64_tr_b16 v[236:237], v103 offset:27648
ds_read_b64_tr_b16 v[238:239], v103 offset:28416
s_add_u32 m0, s60, 13312
s_nop 0
buffer_load_dwordx4 v97, s[44:47], s57 offen lds
v_mfma_f32_32x32x16_bf16 v[148:163], v[216:219], v[224:227], v[148:163]
ds_read_b64_tr_b16 v[240:241], v102 offset:27712
ds_read_b64_tr_b16 v[242:243], v102 offset:28480
v_mfma_f32_32x32x16_bf16 v[164:179], v[216:219], v[228:231], v[164:179]
ds_read_b128 v[84:87], v255 offset:16384
ds_read_b128 v[88:91], v255 offset:20480
s_add_u32 m0, s60, 14336
s_nop 0
buffer_load_dwordx4 v98, s[44:47], s57 offen lds
v_mfma_f32_32x32x16_bf16 v[180:195], v[220:223], v[224:227], v[180:195]
v_mfma_f32_32x32x16_bf16 v[196:211], v[220:223], v[228:231], v[196:211]
s_waitcnt vmcnt(10) lgkmcnt(0)
s_barrier
v_mfma_f32_32x32x16_bf16 v[116:131], v[232:235], v[244:247], v[116:131]
ds_read_b64_tr_b16 v[212:213], v102 offset:36864
ds_read_b64_tr_b16 v[214:215], v102 offset:37632
ds_read_b64_tr_b16 v[216:217], v103 offset:36864
s_add_u32 s52, s52, 1
s_cmp_eq_u32 s52, 10
s_cselect_b32 s52, 0, s52
s_cselect_b32 s48, 4294966144, s49
s_add_u32 s53, s53, s48
s_add_u32 s54, s54, s48
s_mul_i32 s48, s48, 1536
s_add_u32 s56, s56, s48
s_add_u32 m0, s59, 65536
s_nop 0
buffer_load_dwordx4 v100, s[40:43], s53 offen lds
v_mfma_f32_32x32x16_bf16 v[132:147], v[232:235], v[248:251], v[132:147]
ds_read_b64_tr_b16 v[218:219], v103 offset:37632
ds_read_b64_tr_b16 v[220:221], v102 offset:36928
ds_read_b64_tr_b16 v[222:223], v102 offset:37696
v_mfma_f32_32x32x16_bf16 v[148:163], v[236:239], v[244:247], v[148:163]
s_add_u32 m0, s59, 66560
s_nop 0
buffer_load_dwordx4 v101, s[40:43], s53 offen lds
v_mfma_f32_32x32x16_bf16 v[164:179], v[236:239], v[248:251], v[164:179]
v_mfma_f32_32x32x16_bf16 v[180:195], v[240:243], v[244:247], v[180:195]
s_add_u32 m0, s60, 24576
s_nop 0
buffer_load_dwordx4 v96, s[44:47], s56 offen lds
v_mfma_f32_32x32x16_bf16 v[196:211], v[240:243], v[248:251], v[196:211]
s_waitcnt lgkmcnt(0)
v_mfma_f32_32x32x16_bf16 v[116:131], v[212:215], v[72:75], v[116:131]
ds_read_b64_tr_b16 v[232:233], v102 offset:39936
ds_read_b64_tr_b16 v[234:235], v102 offset:40704
ds_read_b64_tr_b16 v[236:237], v103 offset:39936
v_mfma_f32_32x32x16_bf16 v[132:147], v[212:215], v[76:79], v[132:147]
ds_read_b64_tr_b16 v[238:239], v103 offset:40704
ds_read_b64_tr_b16 v[240:241], v102 offset:40000
ds_read_b64_tr_b16 v[242:243], v102 offset:40768
s_add_u32 m0, s60, 25600
s_nop 0
buffer_load_dwordx4 v97, s[44:47], s56 offen lds
v_mfma_f32_32x32x16_bf16 v[148:163], v[216:219], v[72:75], v[148:163]
v_mfma_f32_32x32x16_bf16 v[164:179], v[216:219], v[76:79], v[164:179]
s_add_u32 m0, s60, 26624
s_nop 0
buffer_load_dwordx4 v98, s[44:47], s56 offen lds
v_mfma_f32_32x32x16_bf16 v[180:195], v[220:223], v[72:75], v[180:195]
v_mfma_f32_32x32x16_bf16 v[196:211], v[220:223], v[76:79], v[196:211]
s_sub_u32 s58, s58, 1
s_cmp_lg_u32 s58, 0
s_waitcnt vmcnt(8) lgkmcnt(0)
s_cbranch_scc1 g1loop_40
s_barrier
v_mfma_f32_32x32x16_bf16 v[116:131], v[232:235], v[84:87], v[116:131]
ds_read_b64_tr_b16 v[212:213], v102 offset:0
ds_read_b64_tr_b16 v[214:215], v102 offset:768
ds_read_b128 v[224:227], v252 offset:0
s_add_u32 m0, s59, 67584
s_nop 0
buffer_load_dwordx4 v100, s[40:43], s54 offen lds
v_mfma_f32_32x32x16_bf16 v[132:147], v[232:235], v[88:91], v[132:147]
ds_read_b128 v[228:231], v252 offset:4096
ds_read_b64_tr_b16 v[216:217], v103 offset:0
ds_read_b64_tr_b16 v[218:219], v103 offset:768
v_mfma_f32_32x32x16_bf16 v[148:163], v[236:239], v[84:87], v[148:163]
ds_read_b64_tr_b16 v[220:221], v102 offset:64
ds_read_b64_tr_b16 v[222:223], v102 offset:832
s_add_u32 m0, s59, 68608
s_nop 0
buffer_load_dwordx4 v101, s[40:43], s54 offen lds
v_mfma_f32_32x32x16_bf16 v[164:179], v[236:239], v[88:91], v[164:179]
ds_read_b128 v[72:75], v254 offset:0
ds_read_b128 v[76:79], v254 offset:4096
v_mfma_f32_32x32x16_bf16 v[180:195], v[240:243], v[84:87], v[180:195]
s_add_u32 s57, s56, 98304
s_add_u32 m0, s60, 36864
s_nop 0
buffer_load_dwordx4 v96, s[44:47], s57 offen lds
v_mfma_f32_32x32x16_bf16 v[196:211], v[240:243], v[88:91], v[196:211]
s_waitcnt lgkmcnt(2)
v_mfma_f32_32x32x16_bf16 v[116:131], v[212:215], v[224:227], v[116:131]
ds_read_b64_tr_b16 v[232:233], v102 offset:3072
ds_read_b64_tr_b16 v[234:235], v102 offset:3840
ds_read_b128 v[244:247], v253 offset:0
v_mfma_f32_32x32x16_bf16 v[132:147], v[212:215], v[228:231], v[132:147]
ds_read_b128 v[248:251], v253 offset:4096
ds_read_b64_tr_b16 v[236:237], v103 offset:3072
ds_read_b64_tr_b16 v[238:239], v103 offset:3840
s_add_u32 m0, s60, 37888
s_nop 0
buffer_load_dwordx4 v97, s[44:47], s57 offen lds
v_mfma_f32_32x32x16_bf16 v[148:163], v[216:219], v[224:227], v[148:163]
ds_read_b64_tr_b16 v[240:241], v102 offset:3136
ds_read_b64_tr_b16 v[242:243], v102 offset:3904
v_mfma_f32_32x32x16_bf16 v[164:179], v[216:219], v[228:231], v[164:179]
ds_read_b128 v[84:87], v255 offset:0
ds_read_b128 v[88:91], v255 offset:4096
s_add_u32 m0, s60, 38912
s_nop 0
buffer_load_dwordx4 v98, s[44:47], s57 offen lds
v_mfma_f32_32x32x16_bf16 v[180:195], v[220:223], v[224:227], v[180:195]
v_mfma_f32_32x32x16_bf16 v[196:211], v[220:223], v[228:231], v[196:211]
buffer_load_dword v3, off, s[32:35], 0 sc1
s_and_b32 s37, s25, 7
s_lshl_b32 s37, s37, 5
s_lshl_b32 s38, s37, 7
s_add_u32 s38, s38, 19169280
s_mov_b64 exec, 65535
buffer_load_dword v2, v4, s[28:31], s38 offen sc1
s_mov_b64 exec, -1
s_waitcnt vmcnt(12) lgkmcnt(0)
s_barrier
v_mfma_f32_32x32x16_bf16 v[116:131], v[232:235], v[244:247], v[116:131]
ds_read_b64_tr_b16 v[212:213], v102 offset:12288
ds_read_b64_tr_b16 v[214:215], v102 offset:13056
ds_read_b64_tr_b16 v[216:217], v103 offset:12288
v_mfma_f32_32x32x16_bf16 v[132:147], v[232:235], v[248:251], v[132:147]
ds_read_b64_tr_b16 v[218:219], v103 offset:13056
ds_read_b64_tr_b16 v[220:221], v102 offset:12352
ds_read_b64_tr_b16 v[222:223], v102 offset:13120
v_mfma_f32_32x32x16_bf16 v[148:163], v[236:239], v[244:247], v[148:163]
v_mfma_f32_32x32x16_bf16 v[164:179], v[236:239], v[248:251], v[164:179]
v_mfma_f32_32x32x16_bf16 v[180:195], v[240:243], v[244:247], v[180:195]
v_and_b32 v100, 7, v1
v_and_b32 v6, 24, v1
v_lshl_add_u32 v100, v6, 2, v100
v_lshlrev_b32 v100, 3, v100
s_lshr_b32 s50, s50, 2
s_mul_i32 s48, s62, 2
s_add_u32 s50, s50, s48
s_lshl_b32 s53, s50, 10
s_add_u32 s53, s53, 18874368
v_mfma_f32_32x32x16_bf16 v[196:211], v[240:243], v[248:251], v[196:211]
v_and_b32 v6, 15, v1
v_bfe_u32 v7, v1, 4, 1
v_mul_u32_u24 v9, 1536, v7
v_lshrrev_b32 v8, 5, v1
s_waitcnt lgkmcnt(0)
v_mfma_f32_32x32x16_bf16 v[116:131], v[212:215], v[72:75], v[116:131]
ds_read_b64_tr_b16 v[232:233], v102 offset:15360
ds_read_b64_tr_b16 v[234:235], v102 offset:16128
ds_read_b64_tr_b16 v[236:237], v103 offset:15360
v_mfma_f32_32x32x16_bf16 v[132:147], v[212:215], v[76:79], v[132:147]
ds_read_b64_tr_b16 v[238:239], v103 offset:16128
ds_read_b64_tr_b16 v[240:241], v102 offset:15424
ds_read_b64_tr_b16 v[242:243], v102 offset:16192
v_mfma_f32_32x32x16_bf16 v[148:163], v[216:219], v[72:75], v[148:163]
s_movk_i32 s48, 9216
v_mad_u32_u24 v9, v8, s48, v9
v_lshl_add_u32 v9, v6, 1, v9
v_lshlrev_b32 v101, 2, v9
s_mul_i32 s48, s61, 3
s_add_u32 s51, s51, s48
s_add_u32 s48, s51, 0
s_and_b32 s56, s48, -4
s_lshl_b32 s56, s56, 6
s_and_b32 s49, s48, 1
s_lshl_b32 s49, s49, 7
s_add_u32 s56, s56, s49
s_and_b32 s48, s48, 2
s_lshl_b32 s48, s48, 1
s_add_u32 s56, s56, s48
s_add_u32 s56, s56, 18939904
s_add_u32 s48, s51, 1
s_and_b32 s57, s48, -4
s_lshl_b32 s57, s57, 6
s_and_b32 s49, s48, 1
s_lshl_b32 s49, s49, 7
s_add_u32 s57, s57, s49
s_and_b32 s48, s48, 2
s_lshl_b32 s48, s48, 1
s_add_u32 s57, s57, s48
s_add_u32 s57, s57, 18939904
s_add_u32 s48, s51, 2
s_and_b32 s55, s48, -4
s_lshl_b32 s55, s55, 6
s_and_b32 s49, s48, 1
s_lshl_b32 s49, s49, 7
s_add_u32 s55, s55, s49
s_and_b32 s48, s48, 2
s_lshl_b32 s48, s48, 1
s_add_u32 s55, s55, s48
s_add_u32 s55, s55, 18939904
v_mfma_f32_32x32x16_bf16 v[164:179], v[216:219], v[76:79], v[164:179]
v_mfma_f32_32x32x16_bf16 v[180:195], v[220:223], v[72:75], v[180:195]
v_lshl_add_u32 v7, v7, 2, v8
v_lshl_add_u32 v7, v7, 4, v6
v_lshlrev_b32 v97, 4, v7
v_mov_b32 v114, 0
v_mov_b32 v115, 0
v_mov_b32 v99, 0
v_mfma_f32_32x32x16_bf16 v[196:211], v[220:223], v[76:79], v[196:211]
s_waitcnt vmcnt(0) lgkmcnt(0)
s_mov_b32 s37, 100000
tag_41:
v_readfirstlane_b32 s36, v3
s_nop 1
s_cmp_lg_u32 s36, 0
s_cbranch_scc1 tag_42
s_sleep 8
buffer_load_dword v3, off, s[32:35], 0 sc1
s_waitcnt vmcnt(0)
s_sub_u32 s37, s37, 1
s_cbranch_scc0 tag_41
tag_42:
s_mov_b64 exec, 65535
s_mov_b32 s37, 100000
fl_43:
v_cmp_ne_u32 vcc, s36, v2
s_nop 1
s_cmp_eq_u64 vcc, 0
s_cbranch_scc1 fl_44
s_sleep 2
buffer_load_dword v2, v4, s[28:31], s38 offen sc1
s_waitcnt vmcnt(0)
s_sub_u32 s37, s37, 1
s_cbranch_scc0 fl_43
fl_44:
s_mov_b64 exec, -1
s_barrier
v_mfma_f32_32x32x16_bf16 v[116:131], v[232:235], v[84:87], v[116:131]
ds_read_b64_tr_b16 v[212:213], v102 offset:24576
ds_read_b64_tr_b16 v[214:215], v102 offset:25344
ds_read_b128 v[224:227], v252 offset:16384
v_mfma_f32_32x32x16_bf16 v[132:147], v[232:235], v[88:91], v[132:147]
ds_read_b128 v[228:231], v252 offset:20480
ds_read_b64_tr_b16 v[216:217], v103 offset:24576
ds_read_b64_tr_b16 v[218:219], v103 offset:25344
v_mfma_f32_32x32x16_bf16 v[148:163], v[236:239], v[84:87], v[148:163]
ds_read_b64_tr_b16 v[220:221], v102 offset:24640
ds_read_b64_tr_b16 v[222:223], v102 offset:25408
buffer_load_dwordx2 v[104:105], v100, s[28:31], s53 offen offset:0 sc1
buffer_load_dwordx2 v[106:107], v100, s[28:31], s53 offen offset:1024 sc1
v_mfma_f32_32x32x16_bf16 v[164:179], v[236:239], v[88:91], v[164:179]
ds_read_b128 v[72:75], v254 offset:16384
ds_read_b128 v[76:79], v254 offset:20480
buffer_load_dword v108, v101, s[28:31], s56 offen sc1
buffer_load_dword v109, v101, s[28:31], s57 offen sc1
buffer_load_dword v110, v101, s[28:31], s55 offen sc1
s_add_u32 s57, s57, 12288
s_add_u32 s55, s55, 12288
s_add_u32 s56, s56, 12288
v_mfma_f32_32x32x16_bf16 v[180:195], v[240:243], v[84:87], v[180:195]
buffer_load_dword v111, v101, s[28:31], s56 offen sc1
buffer_load_dword v112, v101, s[28:31], s57 offen sc1
buffer_load_dword v113, v101, s[28:31], s55 offen sc1
s_add_u32 s57, s57, 12288
s_add_u32 s55, s55, 12288
s_add_u32 s56, s56, 12288
v_mfma_f32_32x32x16_bf16 v[196:211], v[240:243], v[88:91], v[196:211]
s_mov_b32 exec_hi, 0
buffer_load_dword v114, v101, s[28:31], s56 offen sc1
buffer_load_dword v115, v101, s[28:31], s57 offen sc1
buffer_load_dword v99, v101, s[28:31], s55 offen sc1
s_mov_b32 exec_hi, -1
s_waitcnt lgkmcnt(2)
v_mfma_f32_32x32x16_bf16 v[116:131], v[212:215], v[224:227], v[116:131]
ds_read_b64_tr_b16 v[232:233], v102 offset:27648
ds_read_b64_tr_b16 v[234:235], v102 offset:28416
ds_read_b128 v[244:247], v253 offset:16384
v_mfma_f32_32x32x16_bf16 v[132:147], v[212:215], v[228:231], v[132:147]
ds_read_b128 v[248:251], v253 offset:20480
ds_read_b64_tr_b16 v[236:237], v103 offset:27648
ds_read_b64_tr_b16 v[238:239], v103 offset:28416
v_mfma_f32_32x32x16_bf16 v[148:163], v[216:219], v[224:227], v[148:163]
ds_read_b64_tr_b16 v[240:241], v102 offset:27712
ds_read_b64_tr_b16 v[242:243], v102 offset:28480
buffer_load_dwordx4 v[16:19], v11, s[28:31], s65 offen offset:0 sc1
v_mfma_f32_32x32x16_bf16 v[164:179], v[216:219], v[228:231], v[164:179]
ds_read_b128 v[84:87], v255 offset:16384
ds_read_b128 v[88:91], v255 offset:20480
buffer_load_dwordx4 v[20:23], v11, s[28:31], s65 offen offset:1024 sc1
v_mfma_f32_32x32x16_bf16 v[180:195], v[220:223], v[224:227], v[180:195]
buffer_load_dwordx4 v[24:27], v11, s[28:31], s65 offen offset:2048 sc1
v_mfma_f32_32x32x16_bf16 v[196:211], v[220:223], v[228:231], v[196:211]
buffer_load_dwordx4 v[28:31], v11, s[28:31], s65 offen offset:3072 sc1
s_waitcnt lgkmcnt(0)
s_barrier
v_mfma_f32_32x32x16_bf16 v[116:131], v[232:235], v[244:247], v[116:131]
ds_read_b64_tr_b16 v[212:213], v102 offset:36864
ds_read_b64_tr_b16 v[214:215], v102 offset:37632
ds_read_b64_tr_b16 v[216:217], v103 offset:36864
v_mfma_f32_32x32x16_bf16 v[132:147], v[232:235], v[248:251], v[132:147]
ds_read_b64_tr_b16 v[218:219], v103 offset:37632
ds_read_b64_tr_b16 v[220:221], v102 offset:36928
ds_read_b64_tr_b16 v[222:223], v102 offset:37696
v_mfma_f32_32x32x16_bf16 v[148:163], v[236:239], v[244:247], v[148:163]
buffer_load_dwordx4 v[32:35], v12, s[28:31], s65 offen offset:0 sc1
v_mfma_f32_32x32x16_bf16 v[164:179], v[236:239], v[248:251], v[164:179]
buffer_load_dwordx4 v[36:39], v11, s[28:31], s66 offen offset:0 sc1
v_mfma_f32_32x32x16_bf16 v[180:195], v[240:243], v[244:247], v[180:195]
buffer_load_dwordx4 v[40:43], v11, s[28:31], s66 offen offset:1024 sc1
v_mfma_f32_32x32x16_bf16 v[196:211], v[240:243], v[248:251], v[196:211]
buffer_load_dwordx4 v[44:47], v11, s[28:31], s66 offen offset:2048 sc1
s_waitcnt lgkmcnt(0)
v_mfma_f32_32x32x16_bf16 v[116:131], v[212:215], v[72:75], v[116:131]
ds_read_b64_tr_b16 v[232:233], v102 offset:39936
ds_read_b64_tr_b16 v[234:235], v102 offset:40704
ds_read_b64_tr_b16 v[236:237], v103 offset:39936
v_mfma_f32_32x32x16_bf16 v[132:147], v[212:215], v[76:79], v[132:147]
ds_read_b64_tr_b16 v[238:239], v103 offset:40704
ds_read_b64_tr_b16 v[240:241], v102 offset:40000
ds_read_b64_tr_b16 v[242:243], v102 offset:40768
v_mfma_f32_32x32x16_bf16 v[148:163], v[216:219], v[72:75], v[148:163]
buffer_load_dwordx4 v[48:51], v11, s[28:31], s66 offen offset:3072 sc1
v_mfma_f32_32x32x16_bf16 v[164:179], v[216:219], v[76:79], v[164:179]
buffer_load_dwordx4 v[52:55], v12, s[28:31], s66 offen offset:0 sc1
v_mfma_f32_32x32x16_bf16 v[180:195], v[220:223], v[72:75], v[180:195]
buffer_load_dwordx4 v[56:59], v11, s[28:31], s67 offen offset:0 sc1
v_mfma_f32_32x32x16_bf16 v[196:211], v[220:223], v[76:79], v[196:211]
buffer_load_dwordx4 v[60:63], v11, s[28:31], s67 offen offset:1024 sc1
s_waitcnt lgkmcnt(0)
s_barrier
s_mul_i32 s60, s24, 20480
s_waitcnt vmcnt(12)
v_mfma_f32_32x32x16_bf16 v[116:131], v[232:235], v[84:87], v[116:131]
v_cvt_pk_bf16_f32 v224, -v104, -v104
v_mov_b64 v[226:227], 0
v_lshlrev_b32 v6, 16, v224
v_add_f32_e64 v6, v6, v104
v_cvt_pk_bf16_f32 v225, -v6, 0
v_mfma_f32_32x32x16_bf16 v[132:147], v[232:235], v[88:91], v[132:147]
v_cvt_pk_bf16_f32 v228, -v106, -v106
v_mov_b64 v[230:231], 0
v_lshlrev_b32 v6, 16, v228
v_add_f32 v6, v6, v106
v_cvt_pk_bf16_f32 v229, -v6, 0
v_mfma_f32_32x32x16_bf16 v[148:163], v[236:239], v[84:87], v[148:163]
v_add_f32 v108, v108, v111
v_add_f32 v108, v108, v114
v_cvt_pk_bf16_f32 v213, v108, 0
v_mov_b64 v[214:215], 0
v_lshlrev_b32 v7, 16, v213
v_sub_f32 v8, v108, v7
v_cvt_pk_bf16_f32 v212, v7, v8
v_mfma_f32_32x32x16_bf16 v[164:179], v[236:239], v[88:91], v[164:179]
v_add_f32 v109, v109, v112
v_add_f32 v109, v109, v115
v_cvt_pk_bf16_f32 v217, v109, 0
v_mov_b64 v[218:219], 0
v_lshlrev_b32 v7, 16, v217
v_sub_f32 v8, v109, v7
v_cvt_pk_bf16_f32 v216, v7, v8
v_mfma_f32_32x32x16_bf16 v[180:195], v[240:243], v[84:87], v[180:195]
v_add_f32 v110, v110, v113
v_add_f32 v110, v110, v99
v_cvt_pk_bf16_f32 v221, v110, 0
v_mov_b64 v[222:223], 0
v_lshlrev_b32 v7, 16, v221
v_sub_f32 v8, v110, v7
v_cvt_pk_bf16_f32 v220, v7, v8
v_mfma_f32_32x32x16_bf16 v[196:211], v[240:243], v[88:91], v[196:211]
v_mfma_f32_32x32x16_bf16 v[116:131], v[212:215], v[224:227], v[116:131]
v_rsq_f32 v7, v105
s_nop 0
v_mul_f32 v8, v7, v7
v_mul_f32 v110, 0xc0135761, v7
v_mul_f32 v8, 0x3d372713, v8
v_mul_f32 v111, v110, v8
v_mfma_f32_32x32x16_bf16 v[132:147], v[212:215], v[228:231], v[132:147]
v_rsq_f32 v7, v107
s_nop 0
v_mul_f32 v8, v7, v7
v_mul_f32 v112, 0xc0135761, v7
v_mul_f32 v8, 0x3d372713, v8
v_mul_f32 v113, v112, v8
v_mfma_f32_32x32x16_bf16 v[148:163], v[216:219], v[224:227], v[148:163]
s_add_u32 s49, s51, 0
s_and_b32 s48, s49, 1
s_mul_i32 s48, s48, 512
s_lshr_b32 s49, s49, 1
s_mul_i32 s49, s49, 4096
s_add_u32 s48, s48, s49
s_mul_i32 s49, s50, 98304
s_add_u32 s48, s48, s49
s_add_u32 s53, s48, 10485760
v_mfma_f32_32x32x16_bf16 v[164:179], v[216:219], v[228:231], v[164:179]
s_add_u32 s49, s51, 1
s_and_b32 s48, s49, 1
s_mul_i32 s48, s48, 512
s_lshr_b32 s49, s49, 1
s_mul_i32 s49, s49, 4096
s_add_u32 s48, s48, s49
s_mul_i32 s49, s50, 98304
s_add_u32 s48, s48, s49
s_add_u32 s56, s48, 10485760
v_mfma_f32_32x32x16_bf16 v[180:195], v[220:223], v[224:227], v[180:195]
s_add_u32 s49, s51, 2
s_and_b32 s48, s49, 1
s_mul_i32 s48, s48, 512
s_lshr_b32 s49, s49, 1
s_mul_i32 s49, s49, 4096
s_add_u32 s48, s48, s49
s_mul_i32 s49, s50, 98304
s_add_u32 s48, s48, s49
s_nop 0
s_add_u32 s57, s48, 10485760
v_mfma_f32_32x32x16_bf16 v[196:211], v[220:223], v[228:231], v[196:211]
v_pk_mul_f32 v[232:233], v[116:117], v[116:117]
v_pk_mul_f32 v[234:235], v[118:119], v[118:119]
v_pk_mul_f32 v[236:237], v[120:121], v[120:121]
v_pk_mul_f32 v[238:239], v[122:123], v[122:123]
buffer_load_dwordx4 v[64:67], v11, s[28:31], s67 offen offset:2048 sc1
v_pk_fma_f32 v[232:233], v[232:233], v[110:111], v[110:111] op_sel:[0,1,0] op_sel_hi:[1,1,0]
v_pk_fma_f32 v[234:235], v[234:235], v[110:111], v[110:111] op_sel:[0,1,0] op_sel_hi:[1,1,0]
v_pk_fma_f32 v[236:237], v[236:237], v[110:111], v[110:111] op_sel:[0,1,0] op_sel_hi:[1,1,0]
v_pk_fma_f32 v[238:239], v[238:239], v[110:111], v[110:111] op_sel:[0,1,0] op_sel_hi:[1,1,0]
v_pk_mul_f32 v[232:233], v[232:233], v[116:117]
v_pk_mul_f32 v[234:235], v[234:235], v[118:119]
v_pk_mul_f32 v[236:237], v[236:237], v[120:121]
v_pk_mul_f32 v[238:239], v[238:239], v[122:123]
buffer_load_dwordx4 v[68:71], v11, s[28:31], s67 offen offset:3072 sc1
v_exp_f32 v232, v232
v_exp_f32 v233, v233
v_exp_f32 v234, v234
v_exp_f32 v235, v235
v_exp_f32 v236, v236
v_exp_f32 v237, v237
v_exp_f32 v238, v238
v_exp_f32 v239, v239
buffer_load_dwordx4 v[72:75], v12, s[28:31], s67 offen offset:0 sc1
v_pk_mul_f32 v[116:117], v[116:117], v[124:125]
v_pk_mul_f32 v[118:119], v[118:119], v[126:127]
v_pk_mul_f32 v[120:121], v[120:121], v[128:129]
v_pk_mul_f32 v[122:123], v[122:123], v[130:131]
v_pk_fma_f32 v[232:233], v[232:233], v[104:105], v[104:105] op_sel:[0,1,1] op_sel_hi:[1,1,1]
v_pk_fma_f32 v[234:235], v[234:235], v[104:105], v[104:105] op_sel:[0,1,1] op_sel_hi:[1,1,1]
v_pk_fma_f32 v[236:237], v[236:237], v[104:105], v[104:105] op_sel:[0,1,1] op_sel_hi:[1,1,1]
v_pk_fma_f32 v[238:239], v[238:239], v[104:105], v[104:105] op_sel:[0,1,1] op_sel_hi:[1,1,1]
v_rcp_f32 v232, v232
v_rcp_f32 v233, v233
v_rcp_f32 v234, v234
v_rcp_f32 v235, v235
v_rcp_f32 v236, v236
v_rcp_f32 v237, v237
v_rcp_f32 v238, v238
v_rcp_f32 v239, v239
v_pk_mul_f32 v[116:117], v[116:117], v[232:233]
v_pk_mul_f32 v[118:119], v[118:119], v[234:235]
v_pk_mul_f32 v[120:121], v[120:121], v[236:237]
v_pk_mul_f32 v[122:123], v[122:123], v[238:239]
v_cvt_pk_bf16_f32 v124, v116, v117
v_cvt_pk_bf16_f32 v125, v118, v119
v_cvt_pk_bf16_f32 v126, v120, v121
v_cvt_pk_bf16_f32 v127, v122, v123
buffer_store_dwordx4 v[124:127], v97, s[28:31], s53 offen offset:0 sc1
v_pk_mul_f32 v[232:233], v[132:133], v[132:133]
v_pk_mul_f32 v[234:235], v[134:135], v[134:135]
v_pk_mul_f32 v[236:237], v[136:137], v[136:137]
v_pk_mul_f32 v[238:239], v[138:139], v[138:139]
buffer_load_dwordx4 v[76:79], v11, s[28:31], s68 offen offset:0 sc1
v_pk_fma_f32 v[232:233], v[232:233], v[112:113], v[112:113] op_sel:[0,1,0] op_sel_hi:[1,1,0]
v_pk_fma_f32 v[234:235], v[234:235], v[112:113], v[112:113] op_sel:[0,1,0] op_sel_hi:[1,1,0]
v_pk_fma_f32 v[236:237], v[236:237], v[112:113], v[112:113] op_sel:[0,1,0] op_sel_hi:[1,1,0]
v_pk_fma_f32 v[238:239], v[238:239], v[112:113], v[112:113] op_sel:[0,1,0] op_sel_hi:[1,1,0]
v_pk_mul_f32 v[232:233], v[232:233], v[132:133]
v_pk_mul_f32 v[234:235], v[234:235], v[134:135]
v_pk_mul_f32 v[236:237], v[236:237], v[136:137]
v_pk_mul_f32 v[238:239], v[238:239], v[138:139]
buffer_load_dwordx4 v[80:83], v11, s[28:31], s68 offen offset:1024 sc1
v_exp_f32 v232, v232
v_exp_f32 v233, v233
v_exp_f32 v234, v234
v_exp_f32 v235, v235
v_exp_f32 v236, v236
v_exp_f32 v237, v237
v_exp_f32 v238, v238
v_exp_f32 v239, v239
buffer_load_dwordx4 v[84:87], v11, s[28:31], s68 offen offset:2048 sc1
v_pk_mul_f32 v[132:133], v[132:133], v[140:141]
v_pk_mul_f32 v[134:135], v[134:135], v[142:143]
v_pk_mul_f32 v[136:137], v[136:137], v[144:145]
v_pk_mul_f32 v[138:139], v[138:139], v[146:147]
v_pk_fma_f32 v[232:233], v[232:233], v[106:107], v[106:107] op_sel:[0,1,1] op_sel_hi:[1,1,1]
v_pk_fma_f32 v[234:235], v[234:235], v[106:107], v[106:107] op_sel:[0,1,1] op_sel_hi:[1,1,1]
v_pk_fma_f32 v[236:237], v[236:237], v[106:107], v[106:107] op_sel:[0,1,1] op_sel_hi:[1,1,1]
v_pk_fma_f32 v[238:239], v[238:239], v[106:107], v[106:107] op_sel:[0,1,1] op_sel_hi:[1,1,1]
v_rcp_f32 v232, v232
v_rcp_f32 v233, v233
v_rcp_f32 v234, v234
v_rcp_f32 v235, v235
v_rcp_f32 v236, v236
v_rcp_f32 v237, v237
v_rcp_f32 v238, v238
v_rcp_f32 v239, v239
v_pk_mul_f32 v[132:133], v[132:133], v[232:233]
v_pk_mul_f32 v[134:135], v[134:135], v[234:235]
v_pk_mul_f32 v[136:137], v[136:137], v[236:237]
v_pk_mul_f32 v[138:139], v[138:139], v[238:239]
v_cvt_pk_bf16_f32 v140, v132, v133
v_cvt_pk_bf16_f32 v141, v134, v135
v_cvt_pk_bf16_f32 v142, v136, v137
v_cvt_pk_bf16_f32 v143, v138, v139
buffer_store_dwordx4 v[140:143], v97, s[28:31], s53 offen offset:2048 sc1
v_pk_mul_f32 v[232:233], v[148:149], v[148:149]
v_pk_mul_f32 v[234:235], v[150:151], v[150:151]
v_pk_mul_f32 v[236:237], v[152:153], v[152:153]
v_pk_mul_f32 v[238:239], v[154:155], v[154:155]
buffer_load_dwordx4 v[88:91], v11, s[28:31], s68 offen offset:3072 sc1
v_pk_fma_f32 v[232:233], v[232:233], v[110:111], v[110:111] op_sel:[0,1,0] op_sel_hi:[1,1,0]
v_pk_fma_f32 v[234:235], v[234:235], v[110:111], v[110:111] op_sel:[0,1,0] op_sel_hi:[1,1,0]
v_pk_fma_f32 v[236:237], v[236:237], v[110:111], v[110:111] op_sel:[0,1,0] op_sel_hi:[1,1,0]
v_pk_fma_f32 v[238:239], v[238:239], v[110:111], v[110:111] op_sel:[0,1,0] op_sel_hi:[1,1,0]
v_pk_mul_f32 v[232:233], v[232:233], v[148:149]
v_pk_mul_f32 v[234:235], v[234:235], v[150:151]
v_pk_mul_f32 v[236:237], v[236:237], v[152:153]
v_pk_mul_f32 v[238:239], v[238:239], v[154:155]
buffer_load_dwordx4 v[92:95], v12, s[28:31], s68 offen offset:0 sc1
v_exp_f32 v232, v232
v_exp_f32 v233, v233
v_exp_f32 v234, v234
v_exp_f32 v235, v235
v_exp_f32 v236, v236
v_exp_f32 v237, v237
v_exp_f32 v238, v238
v_exp_f32 v239, v239
s_add_u32 m0, s60, 0
s_nop 0
buffer_load_dwordx4 v11, s[28:31], s70 offen sc1 lds
v_pk_mul_f32 v[148:149], v[148:149], v[156:157]
v_pk_mul_f32 v[150:151], v[150:151], v[158:159]
v_pk_mul_f32 v[152:153], v[152:153], v[160:161]
v_pk_mul_f32 v[154:155], v[154:155], v[162:163]
v_pk_fma_f32 v[232:233], v[232:233], v[104:105], v[104:105] op_sel:[0,1,1] op_sel_hi:[1,1,1]
v_pk_fma_f32 v[234:235], v[234:235], v[104:105], v[104:105] op_sel:[0,1,1] op_sel_hi:[1,1,1]
v_pk_fma_f32 v[236:237], v[236:237], v[104:105], v[104:105] op_sel:[0,1,1] op_sel_hi:[1,1,1]
v_pk_fma_f32 v[238:239], v[238:239], v[104:105], v[104:105] op_sel:[0,1,1] op_sel_hi:[1,1,1]
v_rcp_f32 v232, v232
v_rcp_f32 v233, v233
v_rcp_f32 v234, v234
v_rcp_f32 v235, v235
v_rcp_f32 v236, v236
v_rcp_f32 v237, v237
v_rcp_f32 v238, v238
v_rcp_f32 v239, v239
v_pk_mul_f32 v[148:149], v[148:149], v[232:233]
v_pk_mul_f32 v[150:151], v[150:151], v[234:235]
v_pk_mul_f32 v[152:153], v[152:153], v[236:237]
v_pk_mul_f32 v[154:155], v[154:155], v[238:239]
v_cvt_pk_bf16_f32 v156, v148, v149
v_cvt_pk_bf16_f32 v157, v150, v151
v_cvt_pk_bf16_f32 v158, v152, v153
v_cvt_pk_bf16_f32 v159, v154, v155
buffer_store_dwordx4 v[156:159], v97, s[28:31], s56 offen offset:0 sc1
v_pk_mul_f32 v[232:233], v[164:165], v[164:165]
v_pk_mul_f32 v[234:235], v[166:167], v[166:167]
v_pk_mul_f32 v[236:237], v[168:169], v[168:169]
v_pk_mul_f32 v[238:239], v[170:171], v[170:171]
s_add_u32 m0, s60, 0
s_nop 0
buffer_load_dwordx4 v11, s[28:31], s70 offen offset:1024 sc1 lds
v_pk_fma_f32 v[232:233], v[232:233], v[112:113], v[112:113] op_sel:[0,1,0] op_sel_hi:[1,1,0]
v_pk_fma_f32 v[234:235], v[234:235], v[112:113], v[112:113] op_sel:[0,1,0] op_sel_hi:[1,1,0]
v_pk_fma_f32 v[236:237], v[236:237], v[112:113], v[112:113] op_sel:[0,1,0] op_sel_hi:[1,1,0]
v_pk_fma_f32 v[238:239], v[238:239], v[112:113], v[112:113] op_sel:[0,1,0] op_sel_hi:[1,1,0]
v_pk_mul_f32 v[232:233], v[232:233], v[164:165]
v_pk_mul_f32 v[234:235], v[234:235], v[166:167]
v_pk_mul_f32 v[236:237], v[236:237], v[168:169]
v_pk_mul_f32 v[238:239], v[238:239], v[170:171]
s_add_u32 m0, s60, 0
s_nop 0
buffer_load_dwordx4 v11, s[28:31], s70 offen offset:2048 sc1 lds
v_exp_f32 v232, v232
v_exp_f32 v233, v233
v_exp_f32 v234, v234
v_exp_f32 v235, v235
v_exp_f32 v236, v236
v_exp_f32 v237, v237
v_exp_f32 v238, v238
v_exp_f32 v239, v239
s_add_u32 m0, s60, 0
s_nop 0
buffer_load_dwordx4 v11, s[28:31], s70 offen offset:3072 sc1 lds
v_pk_mul_f32 v[164:165], v[164:165], v[172:173]
v_pk_mul_f32 v[166:167], v[166:167], v[174:175]
v_pk_mul_f32 v[168:169], v[168:169], v[176:177]
v_pk_mul_f32 v[170:171], v[170:171], v[178:179]
v_pk_fma_f32 v[232:233], v[232:233], v[106:107], v[106:107] op_sel:[0,1,1] op_sel_hi:[1,1,1]
v_pk_fma_f32 v[234:235], v[234:235], v[106:107], v[106:107] op_sel:[0,1,1] op_sel_hi:[1,1,1]
v_pk_fma_f32 v[236:237], v[236:237], v[106:107], v[106:107] op_sel:[0,1,1] op_sel_hi:[1,1,1]
v_pk_fma_f32 v[238:239], v[238:239], v[106:107], v[106:107] op_sel:[0,1,1] op_sel_hi:[1,1,1]
v_rcp_f32 v232, v232
v_rcp_f32 v233, v233
v_rcp_f32 v234, v234
v_rcp_f32 v235, v235
v_rcp_f32 v236, v236
v_rcp_f32 v237, v237
v_rcp_f32 v238, v238
v_rcp_f32 v239, v239
v_pk_mul_f32 v[164:165], v[164:165], v[232:233]
v_pk_mul_f32 v[166:167], v[166:167], v[234:235]
v_pk_mul_f32 v[168:169], v[168:169], v[236:237]
v_pk_mul_f32 v[170:171], v[170:171], v[238:239]
v_cvt_pk_bf16_f32 v172, v164, v165
v_cvt_pk_bf16_f32 v173, v166, v167
v_cvt_pk_bf16_f32 v174, v168, v169
v_cvt_pk_bf16_f32 v175, v170, v171
buffer_store_dwordx4 v[172:175], v97, s[28:31], s56 offen offset:2048 sc1
v_pk_mul_f32 v[232:233], v[180:181], v[180:181]
v_pk_mul_f32 v[234:235], v[182:183], v[182:183]
v_pk_mul_f32 v[236:237], v[184:185], v[184:185]
v_pk_mul_f32 v[238:239], v[186:187], v[186:187]
s_add_u32 m0, s60, 4096
s_nop 0
s_nop 0
buffer_load_dwordx4 v12, s[28:31], s70 offen sc1 lds
v_pk_fma_f32 v[232:233], v[232:233], v[110:111], v[110:111] op_sel:[0,1,0] op_sel_hi:[1,1,0]
v_pk_fma_f32 v[234:235], v[234:235], v[110:111], v[110:111] op_sel:[0,1,0] op_sel_hi:[1,1,0]
v_pk_fma_f32 v[236:237], v[236:237], v[110:111], v[110:111] op_sel:[0,1,0] op_sel_hi:[1,1,0]
v_pk_fma_f32 v[238:239], v[238:239], v[110:111], v[110:111] op_sel:[0,1,0] op_sel_hi:[1,1,0]
v_pk_mul_f32 v[232:233], v[232:233], v[180:181]
v_pk_mul_f32 v[234:235], v[234:235], v[182:183]
v_pk_mul_f32 v[236:237], v[236:237], v[184:185]
v_pk_mul_f32 v[238:239], v[238:239], v[186:187]
s_add_u32 m0, s60, 5120
s_nop 0
buffer_load_dwordx4 v11, s[28:31], s71 offen sc1 lds
v_exp_f32 v232, v232
v_exp_f32 v233, v233
v_exp_f32 v234, v234
v_exp_f32 v235, v235
v_exp_f32 v236, v236
v_exp_f32 v237, v237
v_exp_f32 v238, v238
v_exp_f32 v239, v239
s_add_u32 m0, s60, 5120
s_nop 0
buffer_load_dwordx4 v11, s[28:31], s71 offen offset:1024 sc1 lds
v_pk_mul_f32 v[180:181], v[180:181], v[188:189]
v_pk_mul_f32 v[182:183], v[182:183], v[190:191]
v_pk_mul_f32 v[184:185], v[184:185], v[192:193]
v_pk_mul_f32 v[186:187], v[186:187], v[194:195]
v_pk_fma_f32 v[232:233], v[232:233], v[104:105], v[104:105] op_sel:[0,1,1] op_sel_hi:[1,1,1]
v_pk_fma_f32 v[234:235], v[234:235], v[104:105], v[104:105] op_sel:[0,1,1] op_sel_hi:[1,1,1]
v_pk_fma_f32 v[236:237], v[236:237], v[104:105], v[104:105] op_sel:[0,1,1] op_sel_hi:[1,1,1]
v_pk_fma_f32 v[238:239], v[238:239], v[104:105], v[104:105] op_sel:[0,1,1] op_sel_hi:[1,1,1]
v_rcp_f32 v232, v232
v_rcp_f32 v233, v233
v_rcp_f32 v234, v234
v_rcp_f32 v235, v235
v_rcp_f32 v236, v236
v_rcp_f32 v237, v237
v_rcp_f32 v238, v238
v_rcp_f32 v239, v239
v_pk_mul_f32 v[180:181], v[180:181], v[232:233]
v_pk_mul_f32 v[182:183], v[182:183], v[234:235]
v_pk_mul_f32 v[184:185], v[184:185], v[236:237]
v_pk_mul_f32 v[186:187], v[186:187], v[238:239]
v_cvt_pk_bf16_f32 v188, v180, v181
v_cvt_pk_bf16_f32 v189, v182, v183
v_cvt_pk_bf16_f32 v190, v184, v185
v_cvt_pk_bf16_f32 v191, v186, v187
buffer_store_dwordx4 v[188:191], v97, s[28:31], s57 offen offset:0 sc1
v_pk_mul_f32 v[232:233], v[196:197], v[196:197]
v_pk_mul_f32 v[234:235], v[198:199], v[198:199]
v_pk_mul_f32 v[236:237], v[200:201], v[200:201]
v_pk_mul_f32 v[238:239], v[202:203], v[202:203]
v_pk_fma_f32 v[232:233], v[232:233], v[112:113], v[112:113] op_sel:[0,1,0] op_sel_hi:[1,1,0]
v_pk_fma_f32 v[234:235], v[234:235], v[112:113], v[112:113] op_sel:[0,1,0] op_sel_hi:[1,1,0]
v_pk_fma_f32 v[236:237], v[236:237], v[112:113], v[112:113] op_sel:[0,1,0] op_sel_hi:[1,1,0]
v_pk_fma_f32 v[238:239], v[238:239], v[112:113], v[112:113] op_sel:[0,1,0] op_sel_hi:[1,1,0]
v_pk_mul_f32 v[232:233], v[232:233], v[196:197]
v_pk_mul_f32 v[234:235], v[234:235], v[198:199]
v_pk_mul_f32 v[236:237], v[236:237], v[200:201]
v_pk_mul_f32 v[238:239], v[238:239], v[202:203]
v_exp_f32 v232, v232
v_exp_f32 v233, v233
v_exp_f32 v234, v234
v_exp_f32 v235, v235
v_exp_f32 v236, v236
v_exp_f32 v237, v237
v_exp_f32 v238, v238
v_exp_f32 v239, v239
v_pk_mul_f32 v[196:197], v[196:197], v[204:205]
v_pk_mul_f32 v[198:199], v[198:199], v[206:207]
v_pk_mul_f32 v[200:201], v[200:201], v[208:209]
v_pk_mul_f32 v[202:203], v[202:203], v[210:211]
v_pk_fma_f32 v[232:233], v[232:233], v[106:107], v[106:107] op_sel:[0,1,1] op_sel_hi:[1,1,1]
v_pk_fma_f32 v[234:235], v[234:235], v[106:107], v[106:107] op_sel:[0,1,1] op_sel_hi:[1,1,1]
v_pk_fma_f32 v[236:237], v[236:237], v[106:107], v[106:107] op_sel:[0,1,1] op_sel_hi:[1,1,1]
v_pk_fma_f32 v[238:239], v[238:239], v[106:107], v[106:107] op_sel:[0,1,1] op_sel_hi:[1,1,1]
v_rcp_f32 v232, v232
v_rcp_f32 v233, v233
v_rcp_f32 v234, v234
v_rcp_f32 v235, v235
v_rcp_f32 v236, v236
v_rcp_f32 v237, v237
v_rcp_f32 v238, v238
v_rcp_f32 v239, v239
v_pk_mul_f32 v[196:197], v[196:197], v[232:233]
v_pk_mul_f32 v[198:199], v[198:199], v[234:235]
v_pk_mul_f32 v[200:201], v[200:201], v[236:237]
v_pk_mul_f32 v[202:203], v[202:203], v[238:239]
v_cvt_pk_bf16_f32 v204, v196, v197
v_cvt_pk_bf16_f32 v205, v198, v199
v_cvt_pk_bf16_f32 v206, v200, v201
v_cvt_pk_bf16_f32 v207, v202, v203
buffer_store_dwordx4 v[204:207], v97, s[28:31], s57 offen offset:2048 sc1
s_movk_i32 s52, 0x303
s_mov_b32 s58, 0
s_mov_b32 s27, 31
s_branch L_join
L_code_end:
.fill 1024, 4, 0xbf810000
.section .rodata,"a"
.p2align 6
.amdhsa_kernel recurrent_scan__spectral_gfnet__geglu_ffn__prompt_kernel
  .amdhsa_next_free_vgpr 256
  .amdhsa_next_free_sgpr 80
  .amdhsa_accum_offset 256
  .amdhsa_group_segment_fixed_size 0
  .amdhsa_kernarg_size 80
  .amdhsa_user_sgpr_count 2
  .amdhsa_user_sgpr_kernarg_segment_ptr 1
  .amdhsa_system_sgpr_workgroup_id_x 1
.end_amdhsa_kernel
```
